```python
import torch

def _softmax(x, axis=-1):
    return torch.softmax(x, dim=axis)
def _gelu(x):
    return torch.nn.functional.gelu(x, approximate="tanh")
def _silu(x):
    return torch.nn.functional.silu(x)
def _sigmoid(x):
    return torch.sigmoid(x)
def _layernorm(x, axis=-1, eps=1e-5):
    m = x.mean(dim=axis, keepdim=True)
    v = x.var(dim=axis, keepdim=True, unbiased=False)
    return (x - m) / torch.sqrt(v + eps)
def _scatter_add(tgt, idx, src, axis=0):
    return tgt.clone().index_add_(axis, idx, src)
def _segment_sum(src, seg, n):
    out = torch.zeros((n,) + src.shape[1:], dtype=src.dtype)
    return out.index_add_(0, seg, src)
def _pad(x, pw):
    flat = tuple(v for pair in reversed(pw) for v in pair)
    return torch.nn.functional.pad(x, flat)

kernel_name = 'standalone__memory_aug_memorizing_tr__prompt'

def setup_inputs():

    _w = (lambda a: (lambda t: t.to(torch.bfloat16) if t.is_floating_point() else t)(torch.as_tensor(a)))
    B, H, S, D = 1, 32, 2048, 192
    M, K = 2048, 2
    return {
        "q": _w((lambda *s: torch.randn(*s, dtype=torch.bfloat16) * 0.8)(B, H, S, D)),
        "k": _w((lambda *s: torch.randn(*s, dtype=torch.bfloat16) * 0.8)(B, H, S, D)),
        "v": _w((lambda *s: torch.randn(*s, dtype=torch.bfloat16) * 0.05)(B, H, S, D)),
        "mem_k": _w((lambda *s: torch.randn(*s, dtype=torch.bfloat16) * 0.8)(B, H, M, D)),
        "mem_v": _w((lambda *s: torch.randn(*s, dtype=torch.bfloat16) * 0.05)(B, H, M, D)),
        "idx": _w(torch.randint(0, M, (B, H, S, K)).to(torch.int64)),
        "gate_bias": _w((lambda *s: torch.randn(*s, dtype=torch.bfloat16) * 0.2)(H)),
    }

def reference(q, k, v, mem_k, mem_v, idx, gate_bias):
    B, H, S, D = q.shape
    K = idx.shape[-1]
    scale = D ** -0.5
    sl = torch.einsum("bhqd,bhkd->bhqk", q, k) * scale
    cm = torch.tril(torch.ones((S, S), dtype=q.dtype))
    sl = torch.where(cm[None, None] > 0, sl, -1e9)
    pl = _softmax(sl, axis=-1)
    ol = torch.einsum("bhqk,bhkd->bhqd", pl, v)
    idx_e = (lambda x, n, axis: torch.repeat_interleave(x, n, dim=axis))(idx.reshape(B, H, S * K)[..., None], D, axis=-1)
    mk = (lambda x, i, axis: torch.take_along_dim(x, i, dim=axis))(mem_k, idx_e, axis=2).reshape(B, H, S, K, D)
    mv = (lambda x, i, axis: torch.take_along_dim(x, i, dim=axis))(mem_v, idx_e, axis=2).reshape(B, H, S, K, D)
    sm = torch.einsum("bhqd,bhqkd->bhqk", q, mk) * scale
    pm = _softmax(sm, axis=-1)
    om = torch.einsum("bhqk,bhqkd->bhqd", pm, mv)
    g = _sigmoid(gate_bias)[None, :, None, None]
    return g * om + (1 - g) * ol
```

```asm
; @launch grid=(256,1,1) block=(512,1,1) lds=163840
.amdgcn_target "amdgcn-amd-amdhsa--gfx950"
.text
.globl standalone__memory_aug_memorizing_tr__prompt_kernel
.p2align 8
.type standalone__memory_aug_memorizing_tr__prompt_kernel,@function
standalone__memory_aug_memorizing_tr__prompt_kernel:
  s_cmp_ge_u32 s2, 256
  s_cbranch_scc1 L_exit
  s_load_dwordx16 s[36:51], s[0:1], 0
  s_getpc_b64 s[62:63]
L_pc:
  s_lshr_b32 s60, s2, 3
  s_lshl_b32 s60, s60, 11
  v_lshrrev_b32 v2, 4, v0
  v_lshl_add_u32 v2, v2, 6, s60
  v_min_u32 v2, L_code_end-L_pc-4, v2
  global_load_dword v100, v2, s[62:63]
  v_lshrrev_b32 v1, 6, v0
  s_and_b32 s52, s2, 31
  v_readfirstlane_b32 s3, v1
  s_lshr_b32 s53, s2, 5
  s_lshl_b32 s54, s53, 2
  s_sub_u32 s54, 60, s54
  s_cmp_lt_u32 s3, 4
  s_cbranch_scc0 L_helper
L_compute:
  s_setprio 2
  v_and_b32 v60, 63, v0
  v_lshrrev_b32 v61, 3, v60
  v_and_b32 v62, 7, v60
  v_mul_u32_u24 v65, 384, v61
  v_lshl_add_u32 v64, v62, 4, v65
  s_add_u32 s60, s54, s3
  s_sub_u32 s55, s60, 1
  s_mul_i32 s60, s60, 12288
  s_add_u32 s61, s60, 6144
  s_mul_i32 s62, s52, 786432
  s_mov_b32 s10, 786432
  s_mov_b32 s11, 0x20000
  s_waitcnt lgkmcnt(0)
  s_add_u32 s8, s36, s62
  s_addc_u32 s9, s37, 0
  s_lshr_b32 s62, s52, 1
  s_lshl_b32 s62, s62, 2
  s_load_dword s63, s[48:49], s62
  s_lshr_b32 s56, s52, 3
  s_setprio 3
  buffer_load_dwordx4 v[0:3], v64, s[8:11], s60 offen offset:0 nt
  buffer_load_dwordx4 v[4:7], v64, s[8:11], s60 offen offset:128 nt
  buffer_load_dwordx4 v[8:11], v64, s[8:11], s60 offen offset:256 nt
  s_setprio 2
  buffer_load_dwordx4 v[12:15], v64, s[8:11], s60 offen offset:3072 nt
  buffer_load_dwordx4 v[16:19], v64, s[8:11], s60 offen offset:3200 nt
  buffer_load_dwordx4 v[20:23], v64, s[8:11], s60 offen offset:3328 nt
  s_setprio 1
  buffer_load_dwordx4 v[24:27], v64, s[8:11], s61 offen offset:0 nt
  buffer_load_dwordx4 v[28:31], v64, s[8:11], s61 offen offset:128 nt
  buffer_load_dwordx4 v[32:35], v64, s[8:11], s61 offen offset:256 nt
  s_setprio 0
  buffer_load_dwordx4 v[36:39], v64, s[8:11], s61 offen offset:3072 nt
  buffer_load_dwordx4 v[40:43], v64, s[8:11], s61 offen offset:3200 nt
  buffer_load_dwordx4 v[44:47], v64, s[8:11], s61 offen offset:3328 nt
  s_setprio 2
  s_branch L_comp2
L_helper:
  s_sub_u32 s55, s3, 4
  v_and_b32 v8, 63, v0
  v_lshlrev_b32 v56, 4, v8
  s_mul_i32 s60, s52, 786432
  s_mul_i32 s101, s55, 3072
  s_mul_i32 s100, s55, 3104
  s_mov_b32 s66, s101
  s_mov_b32 s73, 12288
  s_mov_b32 s14, 786432
  s_mov_b32 s15, 0x20000
  s_mov_b32 s18, 786432
  s_mov_b32 s19, 0x20000
  s_mov_b32 s6, 786432
  s_mov_b32 s7, 0x20000
  s_waitcnt lgkmcnt(0)
  s_add_u32 s12, s38, s60
  s_addc_u32 s13, s39, 0
  s_add_u32 s16, s40, s60
  s_addc_u32 s17, s41, 0
  s_add_u32 m0, s100, 99328
  s_nop 0
  buffer_load_dwordx4 v56, s[12:15], s66 offen offset:0  lds
  buffer_load_dwordx4 v56, s[12:15], s66 offen offset:1024  lds
  buffer_load_dwordx4 v56, s[12:15], s66 offen offset:2048  lds
  s_and_b32 s64, s53, 3
  s_lshl2_add_u32 s64, s55, s64
  s_mul_i32 s64, s64, 3072
  v_lshlrev_b32 v6, 7, v8
  v_add_u32 v6, s64, v6
  v_cmp_lt_u32 vcc, 23, v8
  v_mov_b32 v11, 0x40000000
  s_cmp_lt_u32 s53, 4
  s_cselect_b32 s4, s12, s16
  s_cselect_b32 s5, s13, s17
  v_cndmask_b32 v6, v6, v11, vcc
  buffer_load_dwordx2 v[16:17], v6, s[4:7], 0 offen offset:60
  v_add_u32 v6, 49152, v6
  s_branch L_helper2
L_comp2:
  s_mul_i32 s99, s3, 12864
  v_add_u32 v65, s99, v64
  v_add_u32 v65, 112384, v65
  v_and_b32 v61, 3, v60
  v_bfe_u32 v62, v60, 2, 2
  v_lshrrev_b32 v63, 4, v60
  v_mul_u32_u24 v66, 3104, v61
  v_mul_u32_u24 v67, 384, v62
  v_add_u32 v66, v66, v67
  v_lshl_add_u32 v66, v63, 4, v66
  v_add_u32 v249, 62080, v66
  v_add_u32 v248, 86912, v66
  v_mul_u32_u24 v66, 3104, v62
  v_mul_u32_u24 v67, 384, v63
  v_add_u32 v66, v66, v67
  v_lshl_add_u32 v250, v61, 3, v66
  v_mul_u32_u24 v66, 3200, v61
  v_lshrrev_b32 v67, 1, v61
  v_lshl_add_u32 v66, v67, 6, v66
  v_mul_u32_u24 v67, 400, v62
  v_add3_u32 v66, v66, v67, s99
  v_add_u32 v66, 60928, v66
  v_and_b32 v67, 1, v61
  v_xor_b32 v67, v67, v63
  v_lshl_add_u32 v255, v67, 3, v66
  v_and_b32 v67, 1, v63
  v_lshl_add_u32 v66, v67, 2, v66
  v_lshrrev_b32 v67, 1, v63
  v_mul_u32_u24 v67, 1600, v67
  v_add_u32 v254, v66, v67
  v_mov_b32 v240, 0x3f803f80
  v_mov_b32 v241, 0x3f803f80
  v_mov_b32 v242, 0x3f803f80
  v_mov_b32 v243, 0x3f803f80
  v_bfe_i32 v66, v60, 1, 1
  v_bfe_i32 v67, v60, 5, 1
  v_xor_b32 v66, v66, v67
  v_bfi_b32 v240, v66, 0, v240
  v_bfi_b32 v241, v66, 0, v241
  v_bfi_b32 v242, v66, 0, v242
  v_bfi_b32 v243, v66, 0, v243
  v_bfe_i32 v66, v60, 0, 1
  v_and_b32 v66, 0xaaaaaaaa, v66
  v_or_b32 v204, 0x44444444, v66
  s_mov_b32 s64, 0x10000
  s_mov_b32 s65, 0x1110011
  s_mov_b32 s66, 0x11131111
  s_mov_b32 s67, 0x13331133
  s_mov_b32 s68, 0x33373333
  s_mov_b32 s69, 0x37773377
  s_mov_b32 s70, 0x777f7777
  s_mov_b32 s71, 0x7fff77ff
  s_mov_b32 s72, 0x0
  s_mov_b32 s73, 0x0
  s_mov_b32 s74, 0x11111111
  s_mov_b32 s75, 0x11111111
  s_mov_b32 s76, 0x33333333
  s_mov_b32 s77, 0x33333333
  s_mov_b32 s78, 0x77777777
  s_mov_b32 s79, 0x77777777
  s_mov_b32 s80, 0x11111111
  s_mov_b32 s81, 0x11111111
  s_mov_b32 s82, 0x33333333
  s_mov_b32 s83, 0x33333333
  s_mov_b32 s84, 0x77777777
  s_mov_b32 s85, 0x77777777
  s_mov_b32 s86, 0xffffffff
  s_mov_b32 s87, 0xffffffff
  s_mov_b32 s88, 0x10000
  s_mov_b32 s89, 0x1110011
  s_mov_b32 s90, 0x11131111
  s_mov_b32 s91, 0x13331133
  s_mov_b32 s92, 0x33373333
  s_mov_b32 s93, 0x37773377
  s_mov_b32 s94, 0x777f7777
  s_mov_b32 s95, 0x7fff77ff
  s_mov_b32 s4, 0
  s_mov_b32 s5, -1
  s_mov_b32 s6, 0xffff0000
  s_mov_b32 s7, 0xffff0000
  s_mov_b32 s56, 0
  s_mov_b32 s57, 0x40004000
  s_mov_b32 s96, 0x3dd53b95
  s_mov_b32 s97, 0x3dd53b95
  s_mov_b32 s98, 0xffff0000
  s_waitcnt lgkmcnt(0)
  s_lshl_b32 s62, s63, 16
  s_and_b32 s63, s63, 0xffff0000
  s_bitcmp1_b32 s52, 0
  s_cselect_b32 s62, s63, s62
  v_mov_b32 v48, s62
  v_mul_f32 v48, 0x3fb8aa3b, v48
  v_exp_f32 v48, -v48
  s_nop 0
  v_add_f32 v48, 1.0, v48
  v_rcp_f32 v48, v48
  s_nop 0
  v_cvt_pk_bf16_f32 v48, v48, v48
  v_lshlrev_b32 v48, 16, v48
  v_sub_f32 v48, 1.0, v48
  v_cvt_pk_bf16_f32 v48, v48, v48
  v_lshlrev_b32 v48, 16, v48
  s_nop 0
  v_readfirstlane_b32 s100, v48
  s_waitcnt vmcnt(11)
  v_lshlrev_b32 v48, 16, v0
  v_and_b32 v49, s98, v0
  v_lshlrev_b32 v50, 16, v1
  v_and_b32 v51, s98, v1
  v_lshlrev_b32 v52, 16, v2
  v_and_b32 v53, s98, v2
  v_lshlrev_b32 v54, 16, v3
  v_and_b32 v55, s98, v3
  v_pk_mul_f32 v[48:49], v[48:49], s[96:97]
  v_pk_mul_f32 v[50:51], v[50:51], s[96:97]
  v_pk_mul_f32 v[52:53], v[52:53], s[96:97]
  v_pk_mul_f32 v[54:55], v[54:55], s[96:97]
  v_cvt_pk_bf16_f32 v0, v48, v49
  v_cvt_pk_bf16_f32 v1, v50, v51
  v_cvt_pk_bf16_f32 v2, v52, v53
  v_cvt_pk_bf16_f32 v3, v54, v55
  ds_write_b128 v65, v[0:3] offset:0
  s_waitcnt vmcnt(10)
  v_lshlrev_b32 v48, 16, v4
  v_and_b32 v49, s98, v4
  v_lshlrev_b32 v50, 16, v5
  v_and_b32 v51, s98, v5
  v_lshlrev_b32 v52, 16, v6
  v_and_b32 v53, s98, v6
  v_lshlrev_b32 v54, 16, v7
  v_and_b32 v55, s98, v7
  v_pk_mul_f32 v[48:49], v[48:49], s[96:97]
  v_pk_mul_f32 v[50:51], v[50:51], s[96:97]
  v_pk_mul_f32 v[52:53], v[52:53], s[96:97]
  v_pk_mul_f32 v[54:55], v[54:55], s[96:97]
  v_cvt_pk_bf16_f32 v4, v48, v49
  v_cvt_pk_bf16_f32 v5, v50, v51
  v_cvt_pk_bf16_f32 v6, v52, v53
  v_cvt_pk_bf16_f32 v7, v54, v55
  ds_write_b128 v65, v[4:7] offset:128
  s_waitcnt vmcnt(9)
  v_lshlrev_b32 v48, 16, v8
  v_and_b32 v49, s98, v8
  v_lshlrev_b32 v50, 16, v9
  v_and_b32 v51, s98, v9
  v_lshlrev_b32 v52, 16, v10
  v_and_b32 v53, s98, v10
  v_lshlrev_b32 v54, 16, v11
  v_and_b32 v55, s98, v11
  v_pk_mul_f32 v[48:49], v[48:49], s[96:97]
  v_pk_mul_f32 v[50:51], v[50:51], s[96:97]
  v_pk_mul_f32 v[52:53], v[52:53], s[96:97]
  v_pk_mul_f32 v[54:55], v[54:55], s[96:97]
  v_cvt_pk_bf16_f32 v8, v48, v49
  v_cvt_pk_bf16_f32 v9, v50, v51
  v_cvt_pk_bf16_f32 v10, v52, v53
  v_cvt_pk_bf16_f32 v11, v54, v55
  ds_write_b128 v65, v[8:11] offset:256
  s_waitcnt vmcnt(8)
  v_lshlrev_b32 v48, 16, v12
  v_and_b32 v49, s98, v12
  v_lshlrev_b32 v50, 16, v13
  v_and_b32 v51, s98, v13
  v_lshlrev_b32 v52, 16, v14
  v_and_b32 v53, s98, v14
  v_lshlrev_b32 v54, 16, v15
  v_and_b32 v55, s98, v15
  v_pk_mul_f32 v[48:49], v[48:49], s[96:97]
  v_pk_mul_f32 v[50:51], v[50:51], s[96:97]
  v_pk_mul_f32 v[52:53], v[52:53], s[96:97]
  v_pk_mul_f32 v[54:55], v[54:55], s[96:97]
  v_cvt_pk_bf16_f32 v12, v48, v49
  v_cvt_pk_bf16_f32 v13, v50, v51
  v_cvt_pk_bf16_f32 v14, v52, v53
  v_cvt_pk_bf16_f32 v15, v54, v55
  ds_write_b128 v65, v[12:15] offset:3104
  s_waitcnt vmcnt(7)
  v_lshlrev_b32 v48, 16, v16
  v_and_b32 v49, s98, v16
  v_lshlrev_b32 v50, 16, v17
  v_and_b32 v51, s98, v17
  v_lshlrev_b32 v52, 16, v18
  v_and_b32 v53, s98, v18
  v_lshlrev_b32 v54, 16, v19
  v_and_b32 v55, s98, v19
  v_pk_mul_f32 v[48:49], v[48:49], s[96:97]
  v_pk_mul_f32 v[50:51], v[50:51], s[96:97]
  v_pk_mul_f32 v[52:53], v[52:53], s[96:97]
  v_pk_mul_f32 v[54:55], v[54:55], s[96:97]
  v_cvt_pk_bf16_f32 v16, v48, v49
  v_cvt_pk_bf16_f32 v17, v50, v51
  v_cvt_pk_bf16_f32 v18, v52, v53
  v_cvt_pk_bf16_f32 v19, v54, v55
  ds_write_b128 v65, v[16:19] offset:3232
  s_waitcnt vmcnt(6)
  v_lshlrev_b32 v48, 16, v20
  v_and_b32 v49, s98, v20
  v_lshlrev_b32 v50, 16, v21
  v_and_b32 v51, s98, v21
  v_lshlrev_b32 v52, 16, v22
  v_and_b32 v53, s98, v22
  v_lshlrev_b32 v54, 16, v23
  v_and_b32 v55, s98, v23
  v_pk_mul_f32 v[48:49], v[48:49], s[96:97]
  v_pk_mul_f32 v[50:51], v[50:51], s[96:97]
  v_pk_mul_f32 v[52:53], v[52:53], s[96:97]
  v_pk_mul_f32 v[54:55], v[54:55], s[96:97]
  v_cvt_pk_bf16_f32 v20, v48, v49
  v_cvt_pk_bf16_f32 v21, v50, v51
  v_cvt_pk_bf16_f32 v22, v52, v53
  v_cvt_pk_bf16_f32 v23, v54, v55
  ds_write_b128 v65, v[20:23] offset:3360
  s_waitcnt vmcnt(5)
  v_lshlrev_b32 v48, 16, v24
  v_and_b32 v49, s98, v24
  v_lshlrev_b32 v50, 16, v25
  v_and_b32 v51, s98, v25
  v_lshlrev_b32 v52, 16, v26
  v_and_b32 v53, s98, v26
  v_lshlrev_b32 v54, 16, v27
  v_and_b32 v55, s98, v27
  v_pk_mul_f32 v[48:49], v[48:49], s[96:97]
  v_pk_mul_f32 v[50:51], v[50:51], s[96:97]
  v_pk_mul_f32 v[52:53], v[52:53], s[96:97]
  v_pk_mul_f32 v[54:55], v[54:55], s[96:97]
  v_cvt_pk_bf16_f32 v24, v48, v49
  v_cvt_pk_bf16_f32 v25, v50, v51
  v_cvt_pk_bf16_f32 v26, v52, v53
  v_cvt_pk_bf16_f32 v27, v54, v55
  ds_write_b128 v65, v[24:27] offset:6208
  s_waitcnt vmcnt(4)
  v_lshlrev_b32 v48, 16, v28
  v_and_b32 v49, s98, v28
  v_lshlrev_b32 v50, 16, v29
  v_and_b32 v51, s98, v29
  v_lshlrev_b32 v52, 16, v30
  v_and_b32 v53, s98, v30
  v_lshlrev_b32 v54, 16, v31
  v_and_b32 v55, s98, v31
  v_pk_mul_f32 v[48:49], v[48:49], s[96:97]
  v_pk_mul_f32 v[50:51], v[50:51], s[96:97]
  v_pk_mul_f32 v[52:53], v[52:53], s[96:97]
  v_pk_mul_f32 v[54:55], v[54:55], s[96:97]
  v_cvt_pk_bf16_f32 v28, v48, v49
  v_cvt_pk_bf16_f32 v29, v50, v51
  v_cvt_pk_bf16_f32 v30, v52, v53
  v_cvt_pk_bf16_f32 v31, v54, v55
  ds_write_b128 v65, v[28:31] offset:6336
  s_waitcnt vmcnt(3)
  v_lshlrev_b32 v48, 16, v32
  v_and_b32 v49, s98, v32
  v_lshlrev_b32 v50, 16, v33
  v_and_b32 v51, s98, v33
  v_lshlrev_b32 v52, 16, v34
  v_and_b32 v53, s98, v34
  v_lshlrev_b32 v54, 16, v35
  v_and_b32 v55, s98, v35
  v_pk_mul_f32 v[48:49], v[48:49], s[96:97]
  v_pk_mul_f32 v[50:51], v[50:51], s[96:97]
  v_pk_mul_f32 v[52:53], v[52:53], s[96:97]
  v_pk_mul_f32 v[54:55], v[54:55], s[96:97]
  v_cvt_pk_bf16_f32 v32, v48, v49
  v_cvt_pk_bf16_f32 v33, v50, v51
  v_cvt_pk_bf16_f32 v34, v52, v53
  v_cvt_pk_bf16_f32 v35, v54, v55
  ds_write_b128 v65, v[32:35] offset:6464
  s_waitcnt vmcnt(2)
  v_lshlrev_b32 v48, 16, v36
  v_and_b32 v49, s98, v36
  v_lshlrev_b32 v50, 16, v37
  v_and_b32 v51, s98, v37
  v_lshlrev_b32 v52, 16, v38
  v_and_b32 v53, s98, v38
  v_lshlrev_b32 v54, 16, v39
  v_and_b32 v55, s98, v39
  v_pk_mul_f32 v[48:49], v[48:49], s[96:97]
  v_pk_mul_f32 v[50:51], v[50:51], s[96:97]
  v_pk_mul_f32 v[52:53], v[52:53], s[96:97]
  v_pk_mul_f32 v[54:55], v[54:55], s[96:97]
  v_cvt_pk_bf16_f32 v36, v48, v49
  v_cvt_pk_bf16_f32 v37, v50, v51
  v_cvt_pk_bf16_f32 v38, v52, v53
  v_cvt_pk_bf16_f32 v39, v54, v55
  ds_write_b128 v65, v[36:39] offset:9312
  s_waitcnt vmcnt(1)
  v_lshlrev_b32 v48, 16, v40
  v_and_b32 v49, s98, v40
  v_lshlrev_b32 v50, 16, v41
  v_and_b32 v51, s98, v41
  v_lshlrev_b32 v52, 16, v42
  v_and_b32 v53, s98, v42
  v_lshlrev_b32 v54, 16, v43
  v_and_b32 v55, s98, v43
  v_pk_mul_f32 v[48:49], v[48:49], s[96:97]
  v_pk_mul_f32 v[50:51], v[50:51], s[96:97]
  v_pk_mul_f32 v[52:53], v[52:53], s[96:97]
  v_pk_mul_f32 v[54:55], v[54:55], s[96:97]
  v_cvt_pk_bf16_f32 v40, v48, v49
  v_cvt_pk_bf16_f32 v41, v50, v51
  v_cvt_pk_bf16_f32 v42, v52, v53
  v_cvt_pk_bf16_f32 v43, v54, v55
  ds_write_b128 v65, v[40:43] offset:9440
  s_waitcnt vmcnt(0)
  v_lshlrev_b32 v48, 16, v44
  v_and_b32 v49, s98, v44
  v_lshlrev_b32 v50, 16, v45
  v_and_b32 v51, s98, v45
  v_lshlrev_b32 v52, 16, v46
  v_and_b32 v53, s98, v46
  v_lshlrev_b32 v54, 16, v47
  v_and_b32 v55, s98, v47
  v_pk_mul_f32 v[48:49], v[48:49], s[96:97]
  v_pk_mul_f32 v[50:51], v[50:51], s[96:97]
  v_pk_mul_f32 v[52:53], v[52:53], s[96:97]
  v_pk_mul_f32 v[54:55], v[54:55], s[96:97]
  v_cvt_pk_bf16_f32 v44, v48, v49
  v_cvt_pk_bf16_f32 v45, v50, v51
  v_cvt_pk_bf16_f32 v46, v52, v53
  v_cvt_pk_bf16_f32 v47, v54, v55
  ds_write_b128 v65, v[44:47] offset:9568
  v_min_u32 v252, v248, v249
  v_add_u32 v252, s99, v252
  ds_read_b128 v[96:99], v252 offset:50304
  ds_read_b128 v[100:103], v252 offset:50368
  ds_read_b128 v[104:107], v252 offset:50432
  ds_read_b128 v[108:111], v252 offset:50496
  ds_read_b128 v[112:115], v252 offset:50560
  ds_read_b128 v[116:119], v252 offset:50624
  ds_read_b128 v[120:123], v252 offset:51840
  ds_read_b128 v[124:127], v252 offset:51904
  ds_read_b128 v[128:131], v252 offset:51968
  ds_read_b128 v[132:135], v252 offset:52032
  ds_read_b128 v[136:139], v252 offset:52096
  ds_read_b128 v[140:143], v252 offset:52160
  s_waitcnt lgkmcnt(0)
  s_barrier
L_first1:
  ds_read_b128 v[208:211], v248 offset:12416
  ds_read_b128 v[212:215], v248 offset:12480
  ds_read_b128 v[216:219], v248 offset:12544
  ds_read_b128 v[220:223], v248 offset:12608
  ds_read_b128 v[224:227], v248 offset:12672
  ds_read_b128 v[228:231], v248 offset:12736
  ds_read_b128 v[232:235], v248 offset:13952
  ds_read_b128 v[236:239], v248 offset:14016
  v_mov_b64 v[0:1], 0
  v_mov_b64 v[2:3], 0
  v_mov_b64 v[4:5], 0
  v_mov_b64 v[6:7], 0
  v_mov_b64 v[8:9], 0
  v_mov_b64 v[10:11], 0
  v_mov_b64 v[12:13], 0
  v_mov_b64 v[14:15], 0
  v_mov_b64 v[16:17], 0
  v_mov_b64 v[18:19], 0
  v_mov_b64 v[20:21], 0
  v_mov_b64 v[22:23], 0
  s_waitcnt lgkmcnt(7)
  v_mfma_f32_16x16x32_bf16 v[144:147], v[208:211], v[96:99], 0
  v_mov_b64 v[24:25], 0
  v_mov_b64 v[26:27], 0
  v_mfma_f32_16x16x32_bf16 v[148:151], v[208:211], v[120:123], 0
  ds_read_b128 v[208:211], v248 offset:14080
  v_mov_b64 v[28:29], 0
  s_waitcnt lgkmcnt(6)
  v_mfma_f32_16x16x32_bf16 v[144:147], v[212:215], v[100:103], v[144:147]
  v_mov_b64 v[30:31], 0
  v_mov_b64 v[32:33], 0
  v_mfma_f32_16x16x32_bf16 v[148:151], v[212:215], v[124:127], v[148:151]
  ds_read_b128 v[212:215], v248 offset:14144
  v_mov_b64 v[34:35], 0
  v_mfma_f32_16x16x32_bf16 v[144:147], v[216:219], v[104:107], v[144:147]
  v_mov_b64 v[36:37], 0
  v_mov_b64 v[38:39], 0
  v_mfma_f32_16x16x32_bf16 v[148:151], v[216:219], v[128:131], v[148:151]
  ds_read_b128 v[216:219], v248 offset:14208
  v_mov_b64 v[40:41], 0
  s_waitcnt lgkmcnt(5)
  v_mfma_f32_16x16x32_bf16 v[144:147], v[220:223], v[108:111], v[144:147]
  v_mov_b64 v[42:43], 0
  v_mov_b64 v[44:45], 0
  v_mfma_f32_16x16x32_bf16 v[148:151], v[220:223], v[132:135], v[148:151]
  ds_read_b128 v[220:223], v248 offset:14272
  v_mov_b64 v[46:47], 0
  v_mfma_f32_16x16x32_bf16 v[144:147], v[224:227], v[112:115], v[144:147]
  v_mov_b64 v[48:49], 0
  v_mov_b64 v[50:51], 0
  v_mfma_f32_16x16x32_bf16 v[148:151], v[224:227], v[136:139], v[148:151]
  v_mov_b64 v[52:53], 0
  v_mov_b64 v[54:55], 0
  v_mfma_f32_16x16x32_bf16 v[144:147], v[228:231], v[116:119], v[144:147]
  v_mov_b64 v[56:57], 0
  v_mov_b64 v[58:59], 0
  v_mfma_f32_16x16x32_bf16 v[148:151], v[228:231], v[140:143], v[148:151]
  v_mov_b64 v[60:61], 0
  v_mov_b64 v[62:63], 0
  s_waitcnt lgkmcnt(3)
  v_mfma_f32_16x16x32_bf16 v[152:155], v[232:235], v[96:99], 0
  v_mov_b64 v[64:65], 0
  v_mov_b64 v[66:67], 0
  v_mfma_f32_16x16x32_bf16 v[156:159], v[232:235], v[120:123], 0
  v_mov_b64 v[68:69], 0
  v_mov_b64 v[70:71], 0
  v_mfma_f32_16x16x32_bf16 v[152:155], v[236:239], v[100:103], v[152:155]
  v_mov_b64 v[72:73], 0
  v_mov_b64 v[74:75], 0
  v_mfma_f32_16x16x32_bf16 v[156:159], v[236:239], v[124:127], v[156:159]
  v_mov_b64 v[76:77], 0
  v_mov_b64 v[78:79], 0
  v_mfma_f32_16x16x32_bf16 v[152:155], v[208:211], v[104:107], v[152:155]
  v_mov_b64 v[80:81], 0
  v_mov_b64 v[82:83], 0
  v_mfma_f32_16x16x32_bf16 v[156:159], v[208:211], v[128:131], v[156:159]
  v_mov_b64 v[84:85], 0
  v_mov_b64 v[86:87], 0
  s_waitcnt lgkmcnt(0)
  v_mfma_f32_16x16x32_bf16 v[152:155], v[212:215], v[108:111], v[152:155]
  v_mov_b64 v[88:89], 0
  v_mov_b64 v[90:91], 0
  v_mfma_f32_16x16x32_bf16 v[156:159], v[212:215], v[132:135], v[156:159]
  v_mov_b64 v[92:93], 0
  v_mov_b64 v[94:95], 0
  v_mfma_f32_16x16x32_bf16 v[152:155], v[216:219], v[112:115], v[152:155]
  v_mov_b64 v[200:201], 0
  v_mov_b64 v[202:203], 0
  v_mfma_f32_16x16x32_bf16 v[156:159], v[216:219], v[136:139], v[156:159]
  v_mfma_f32_16x16x32_bf16 v[152:155], v[220:223], v[116:119], v[152:155]
  v_mfma_f32_16x16x32_bf16 v[156:159], v[220:223], v[140:143], v[156:159]
  v_swap_b32 v248, v249
  s_nop 5
  s_cmp_eq_u32 s56, 0
  s_cbranch_scc1 L_nomask1
  v_mov_b32 v251, 0xff800000
  v_cndmask_b32 v144, v144, v251, s[64:65]
  v_cndmask_b32 v145, v145, v251, s[66:67]
  v_cndmask_b32 v146, v146, v251, s[68:69]
  v_cndmask_b32 v147, v147, v251, s[70:71]
  v_cndmask_b32 v148, v148, v251, s[72:73]
  v_cndmask_b32 v149, v149, v251, s[74:75]
  v_cndmask_b32 v150, v150, v251, s[76:77]
  v_cndmask_b32 v151, v151, v251, s[78:79]
  v_cndmask_b32 v152, v152, v251, s[80:81]
  v_cndmask_b32 v153, v153, v251, s[82:83]
  v_cndmask_b32 v154, v154, v251, s[84:85]
  v_cndmask_b32 v155, v155, v251, s[86:87]
  v_cndmask_b32 v156, v156, v251, s[88:89]
  v_cndmask_b32 v157, v157, v251, s[90:91]
  v_cndmask_b32 v158, v158, v251, s[92:93]
  v_cndmask_b32 v159, v159, v251, s[94:95]
L_nomask1:
  v_max3_f32 v252, v144, v145, v146
  v_max3_f32 v252, v252, v147, v152
  v_max3_f32 v252, v252, v153, v154
  v_max_f32 v252, v252, v155
  v_max3_f32 v246, v148, v149, v150
  v_max3_f32 v246, v246, v151, v156
  v_max3_f32 v246, v246, v157, v158
  v_max_f32 v246, v246, v159
  s_nop 1
  v_permlane32_swap_b32 v252, v246
  v_max_f32 v252, v252, v246
  v_mov_b32 v246, v252
  s_nop 1
  v_permlane16_swap_b32 v252, v246
  v_max_f32 v252, v252, v246
  v_mov_b32 v246, v252
  s_nop 1
  v_permlane32_swap_b32 v252, v246
  v_sub_f32 v252, 0xc1800000, v252
  v_sub_f32 v246, 0xc1800000, v246
  v_mov_b32 v253, v252
  v_mov_b32 v247, v246
  s_sub_u32 s55, s55, 1
  v_pk_add_f32 v[144:145], v[144:145], v[252:253]
  v_pk_add_f32 v[146:147], v[146:147], v[252:253]
  v_pk_add_f32 v[148:149], v[148:149], v[246:247]
  v_pk_add_f32 v[150:151], v[150:151], v[246:247]
  v_pk_add_f32 v[152:153], v[152:153], v[252:253]
  v_pk_add_f32 v[154:155], v[154:155], v[252:253]
  v_pk_add_f32 v[156:157], v[156:157], v[246:247]
  v_pk_add_f32 v[158:159], v[158:159], v[246:247]
  v_mov_b64 v[192:193], v[252:253]
  v_mov_b64 v[194:195], v[252:253]
  v_mov_b64 v[196:197], v[246:247]
  v_mov_b64 v[198:199], v[246:247]
  s_barrier
  ds_read_b128 v[208:211], v248 offset:0
  ds_read_b128 v[212:215], v248 offset:64
  ds_read_b128 v[216:219], v248 offset:128
  ds_read_b128 v[220:223], v248 offset:192
  ds_read_b128 v[224:227], v248 offset:256
  ds_read_b128 v[228:231], v248 offset:320
  ds_read_b128 v[232:235], v248 offset:1536
  v_exp_f32 v244, v144
  v_exp_f32 v245, v145
  v_exp_f32 v246, v146
  v_exp_f32 v247, v147
  v_exp_f32 v205, v148
  v_cvt_pk_bf16_f32 v176, v244, v245
  v_cvt_pk_bf16_f32 v177, v246, v247
  v_exp_f32 v206, v149
  s_nop 0
  v_cvt_pk_bf16_f32 v180, v205, v206
  v_or3_b32 v251, v176, v177, v180
  v_exp_f32 v244, v150
  s_waitcnt lgkmcnt(6)
  s_cbranch_scc1 L_ev0
  s_bitcmp1_b32 s3, 1
  s_cbranch_scc1 L_step0b
  s_branch L_step0
.p2align 6
L_step0b:
  v_mfma_f32_16x16x32_bf16 v[160:163], v[208:211], v[96:99], v[192:195]
  s_waitcnt lgkmcnt(5)
  ds_read_b128 v[236:239], v248 offset:1600
  v_mfma_f32_16x16x32_bf16 v[160:163], v[212:215], v[100:103], v[160:163]
  s_waitcnt lgkmcnt(5)
  v_exp_f32 v245, v151
  v_mfma_f32_16x16x32_bf16 v[160:163], v[216:219], v[104:107], v[160:163]
  s_waitcnt lgkmcnt(4)
  v_exp_f32 v246, v152
  v_mfma_f32_16x16x32_bf16 v[160:163], v[220:223], v[108:111], v[160:163]
  s_waitcnt lgkmcnt(3)
  v_exp_f32 v247, v153
  v_mfma_f32_16x16x32_bf16 v[160:163], v[224:227], v[112:115], v[160:163]
  s_waitcnt lgkmcnt(2)
  v_exp_f32 v205, v154
  v_mfma_f32_16x16x32_bf16 v[160:163], v[228:231], v[116:119], v[160:163]
  v_exp_f32 v206, v155
  v_mfma_f32_16x16x32_bf16 v[164:167], v[208:211], v[120:123], v[196:199]
  ds_read_b128 v[208:211], v248 offset:1664
  v_cvt_pk_bf16_f32 v181, v244, v245
  v_mfma_f32_16x16x32_bf16 v[164:167], v[212:215], v[124:127], v[164:167]
  ds_read_b128 v[212:215], v248 offset:1728
  v_cvt_pk_bf16_f32 v178, v246, v247
  v_mfma_f32_16x16x32_bf16 v[164:167], v[216:219], v[128:131], v[164:167]
  ds_read_b128 v[216:219], v248 offset:1792
  v_cvt_pk_bf16_f32 v179, v205, v206
  v_mfma_f32_16x16x32_bf16 v[164:167], v[220:223], v[132:135], v[164:167]
  ds_read_b128 v[220:223], v248 offset:1856
  v_or3_b32 v251, v251, v181, v178
  v_mfma_f32_16x16x32_bf16 v[164:167], v[224:227], v[136:139], v[164:167]
  ds_read_b64_tr_b16 v[224:225], v250 offset:0
  v_mfma_f32_16x16x32_bf16 v[164:167], v[228:231], v[140:143], v[164:167]
  s_waitcnt lgkmcnt(6)
  ds_read_b64_tr_b16 v[226:227], v250 offset:1536
  v_mfma_f32_16x16x32_bf16 v[168:171], v[232:235], v[96:99], v[192:195]
  s_waitcnt lgkmcnt(6)
  v_exp_f32 v244, v156
  v_mfma_f32_16x16x32_bf16 v[168:171], v[236:239], v[100:103], v[168:171]
  s_waitcnt lgkmcnt(5)
  v_exp_f32 v245, v157
  v_mfma_f32_16x16x32_bf16 v[168:171], v[208:211], v[104:107], v[168:171]
  s_waitcnt lgkmcnt(4)
  v_exp_f32 v246, v158
  v_mfma_f32_16x16x32_bf16 v[168:171], v[212:215], v[108:111], v[168:171]
  s_waitcnt lgkmcnt(3)
  v_exp_f32 v247, v159
  v_mfma_f32_16x16x32_bf16 v[168:171], v[216:219], v[112:115], v[168:171]
  s_waitcnt lgkmcnt(2)
  ds_read_b64_tr_b16 v[228:229], v250 offset:32
  v_cvt_pk_bf16_f32 v182, v244, v245
  v_mfma_f32_16x16x32_bf16 v[168:171], v[220:223], v[116:119], v[168:171]
  ds_read_b64_tr_b16 v[230:231], v250 offset:1568
  v_cvt_pk_bf16_f32 v183, v246, v247
  v_mfma_f32_16x16x32_bf16 v[172:175], v[232:235], v[120:123], v[196:199]
  ds_read_b64_tr_b16 v[232:233], v250 offset:64
  v_or3_b32 v251, v251, v179, v182
  v_mfma_f32_16x16x32_bf16 v[172:175], v[236:239], v[124:127], v[172:175]
  ds_read_b64_tr_b16 v[234:235], v250 offset:1600
  v_bitop3_b32 v251, v251, v183, s57 bitop3:0xa8
  v_mfma_f32_16x16x32_bf16 v[172:175], v[208:211], v[128:131], v[172:175]
  ds_read_b64_tr_b16 v[236:237], v250 offset:96
  v_cmp_ne_u32 vcc, 0, v251
  v_mfma_f32_16x16x32_bf16 v[172:175], v[212:215], v[132:135], v[172:175]
  ds_read_b64_tr_b16 v[238:239], v250 offset:1632
  v_mfma_f32_16x16x32_bf16 v[172:175], v[216:219], v[136:139], v[172:175]
  s_cbranch_vccnz L_stub0
L_chkret0:
  v_mfma_f32_16x16x32_bf16 v[172:175], v[220:223], v[140:143], v[172:175]
  s_waitcnt lgkmcnt(6)
  ds_read_b64_tr_b16 v[208:209], v250 offset:128
  ds_read_b64_tr_b16 v[210:211], v250 offset:1664
  v_mfma_f32_16x16x32_bf16 v[0:3], v[224:227], v[176:179], v[0:3]
  v_exp_f32 v244, v160
  v_mfma_f32_16x16x32_bf16 v[4:7], v[224:227], v[180:183], v[4:7]
  s_waitcnt lgkmcnt(6)
  ds_read_b64_tr_b16 v[212:213], v250 offset:160
  ds_read_b64_tr_b16 v[214:215], v250 offset:1696
  v_mfma_f32_16x16x32_bf16 v[8:11], v[228:231], v[176:179], v[8:11]
  v_exp_f32 v245, v161
  v_mfma_f32_16x16x32_bf16 v[12:15], v[228:231], v[180:183], v[12:15]
  s_waitcnt lgkmcnt(6)
  ds_read_b64_tr_b16 v[216:217], v250 offset:192
  ds_read_b64_tr_b16 v[218:219], v250 offset:1728
  v_mfma_f32_16x16x32_bf16 v[16:19], v[232:235], v[176:179], v[16:19]
  v_exp_f32 v246, v162
  v_mfma_f32_16x16x32_bf16 v[20:23], v[232:235], v[180:183], v[20:23]
  s_waitcnt lgkmcnt(6)
  ds_read_b64_tr_b16 v[220:221], v250 offset:224
  ds_read_b64_tr_b16 v[222:223], v250 offset:1760
  v_mfma_f32_16x16x32_bf16 v[24:27], v[236:239], v[176:179], v[24:27]
  v_exp_f32 v247, v163
  v_mfma_f32_16x16x32_bf16 v[28:31], v[236:239], v[180:183], v[28:31]
  s_waitcnt lgkmcnt(6)
  ds_read_b64_tr_b16 v[224:225], v250 offset:256
  ds_read_b64_tr_b16 v[226:227], v250 offset:1792
  v_mfma_f32_16x16x32_bf16 v[32:35], v[208:211], v[176:179], v[32:35]
  v_exp_f32 v205, v164
  v_mfma_f32_16x16x32_bf16 v[36:39], v[208:211], v[180:183], v[36:39]
  s_waitcnt lgkmcnt(6)
  ds_read_b64_tr_b16 v[228:229], v250 offset:288
  v_cvt_pk_bf16_f32 v184, v244, v245
  v_mfma_f32_16x16x32_bf16 v[40:43], v[212:215], v[176:179], v[40:43]
  ds_read_b64_tr_b16 v[230:231], v250 offset:1824
  v_cvt_pk_bf16_f32 v185, v246, v247
  v_mfma_f32_16x16x32_bf16 v[44:47], v[212:215], v[180:183], v[44:47]
  s_waitcnt lgkmcnt(6)
  ds_read_b64_tr_b16 v[232:233], v250 offset:320
  v_add_u32 v252, 12416, v250
  v_mfma_f32_16x16x32_bf16 v[48:51], v[216:219], v[176:179], v[48:51]
  ds_read_b64_tr_b16 v[234:235], v250 offset:1856
  v_add_u32 v253, 0xffff3e00, v250
  v_mfma_f32_16x16x32_bf16 v[52:55], v[216:219], v[180:183], v[52:55]
  s_waitcnt lgkmcnt(6)
  v_exp_f32 v206, v165
  v_smfmac_f32_16x16x64_bf16 v[200:203], v[240:243], v[176:183], v204
  s_barrier
  v_mfma_f32_16x16x32_bf16 v[56:59], v[220:223], v[176:179], v[56:59]
  ds_read_b64_tr_b16 v[236:237], v250 offset:352
  ds_read_b64_tr_b16 v[238:239], v250 offset:1888
  v_mfma_f32_16x16x32_bf16 v[60:63], v[220:223], v[180:183], v[60:63]
  s_waitcnt lgkmcnt(6)
  ds_read_b128 v[208:211], v248 offset:12416
  v_min_u32 v250, v252, v253
  v_mfma_f32_16x16x32_bf16 v[64:67], v[224:227], v[176:179], v[64:67]
  ds_read_b128 v[212:215], v248 offset:12480
  v_cvt_pk_bf16_f32 v188, v205, v206
  v_mfma_f32_16x16x32_bf16 v[68:71], v[224:227], v[180:183], v[68:71]
  s_waitcnt lgkmcnt(6)
  ds_read_b128 v[216:219], v248 offset:12544
  v_mfma_f32_16x16x32_bf16 v[72:75], v[228:231], v[176:179], v[72:75]
  ds_read_b128 v[220:223], v248 offset:12608
  v_or3_b32 v251, v184, v185, v188
  v_mfma_f32_16x16x32_bf16 v[76:79], v[228:231], v[180:183], v[76:79]
  s_waitcnt lgkmcnt(6)
  ds_read_b128 v[224:227], v248 offset:12672
  v_mfma_f32_16x16x32_bf16 v[80:83], v[232:235], v[176:179], v[80:83]
  s_sub_u32 s55, s55, 1
  ds_read_b128 v[228:231], v248 offset:12736
  v_mfma_f32_16x16x32_bf16 v[84:87], v[232:235], v[180:183], v[84:87]
  s_waitcnt lgkmcnt(6)
  ds_read_b128 v[232:235], v248 offset:13952
  v_mfma_f32_16x16x32_bf16 v[88:91], v[236:239], v[176:179], v[88:91]
  s_waitcnt lgkmcnt(6)
  v_exp_f32 v244, v166
  v_mfma_f32_16x16x32_bf16 v[92:95], v[236:239], v[180:183], v[92:95]
  s_cbranch_scc1 L_ev1
L_step1b:
  v_mfma_f32_16x16x32_bf16 v[144:147], v[208:211], v[96:99], v[192:195]
  s_waitcnt lgkmcnt(5)
  ds_read_b128 v[236:239], v248 offset:14016
  v_mfma_f32_16x16x32_bf16 v[144:147], v[212:215], v[100:103], v[144:147]
  s_waitcnt lgkmcnt(5)
  v_exp_f32 v245, v167
  v_mfma_f32_16x16x32_bf16 v[144:147], v[216:219], v[104:107], v[144:147]
  s_waitcnt lgkmcnt(4)
  v_exp_f32 v246, v168
  v_mfma_f32_16x16x32_bf16 v[144:147], v[220:223], v[108:111], v[144:147]
  s_waitcnt lgkmcnt(3)
  v_exp_f32 v247, v169
  v_mfma_f32_16x16x32_bf16 v[144:147], v[224:227], v[112:115], v[144:147]
  s_waitcnt lgkmcnt(2)
  v_exp_f32 v205, v170
  v_mfma_f32_16x16x32_bf16 v[144:147], v[228:231], v[116:119], v[144:147]
  v_exp_f32 v206, v171
  v_mfma_f32_16x16x32_bf16 v[148:151], v[208:211], v[120:123], v[196:199]
  ds_read_b128 v[208:211], v248 offset:14080
  v_cvt_pk_bf16_f32 v189, v244, v245
  v_mfma_f32_16x16x32_bf16 v[148:151], v[212:215], v[124:127], v[148:151]
  ds_read_b128 v[212:215], v248 offset:14144
  v_cvt_pk_bf16_f32 v186, v246, v247
  v_mfma_f32_16x16x32_bf16 v[148:151], v[216:219], v[128:131], v[148:151]
  ds_read_b128 v[216:219], v248 offset:14208
  v_cvt_pk_bf16_f32 v187, v205, v206
  v_mfma_f32_16x16x32_bf16 v[148:151], v[220:223], v[132:135], v[148:151]
  ds_read_b128 v[220:223], v248 offset:14272
  v_or3_b32 v251, v251, v189, v186
  v_mfma_f32_16x16x32_bf16 v[148:151], v[224:227], v[136:139], v[148:151]
  ds_read_b64_tr_b16 v[224:225], v250 offset:0
  v_mfma_f32_16x16x32_bf16 v[148:151], v[228:231], v[140:143], v[148:151]
  s_waitcnt lgkmcnt(6)
  ds_read_b64_tr_b16 v[226:227], v250 offset:1536
  v_swap_b32 v248, v249
  v_mfma_f32_16x16x32_bf16 v[152:155], v[232:235], v[96:99], v[192:195]
  s_waitcnt lgkmcnt(6)
  v_exp_f32 v244, v172
  v_mfma_f32_16x16x32_bf16 v[152:155], v[236:239], v[100:103], v[152:155]
  s_waitcnt lgkmcnt(5)
  v_exp_f32 v245, v173
  v_mfma_f32_16x16x32_bf16 v[152:155], v[208:211], v[104:107], v[152:155]
  s_waitcnt lgkmcnt(4)
  v_exp_f32 v246, v174
  v_mfma_f32_16x16x32_bf16 v[152:155], v[212:215], v[108:111], v[152:155]
  s_waitcnt lgkmcnt(3)
  v_exp_f32 v247, v175
  v_mfma_f32_16x16x32_bf16 v[152:155], v[216:219], v[112:115], v[152:155]
  s_waitcnt lgkmcnt(2)
  ds_read_b64_tr_b16 v[228:229], v250 offset:32
  v_cvt_pk_bf16_f32 v190, v244, v245
  v_mfma_f32_16x16x32_bf16 v[152:155], v[220:223], v[116:119], v[152:155]
  ds_read_b64_tr_b16 v[230:231], v250 offset:1568
  v_cvt_pk_bf16_f32 v191, v246, v247
  v_mfma_f32_16x16x32_bf16 v[156:159], v[232:235], v[120:123], v[196:199]
  ds_read_b64_tr_b16 v[232:233], v250 offset:64
  v_or3_b32 v251, v251, v187, v190
  v_mfma_f32_16x16x32_bf16 v[156:159], v[236:239], v[124:127], v[156:159]
  ds_read_b64_tr_b16 v[234:235], v250 offset:1600
  v_bitop3_b32 v251, v251, v191, s57 bitop3:0xa8
  v_mfma_f32_16x16x32_bf16 v[156:159], v[208:211], v[128:131], v[156:159]
  ds_read_b64_tr_b16 v[236:237], v250 offset:96
  v_cmp_ne_u32 vcc, 0, v251
  v_mfma_f32_16x16x32_bf16 v[156:159], v[212:215], v[132:135], v[156:159]
  ds_read_b64_tr_b16 v[238:239], v250 offset:1632
  v_mfma_f32_16x16x32_bf16 v[156:159], v[216:219], v[136:139], v[156:159]
  s_cbranch_vccnz L_stub1
L_chkret1:
  v_mfma_f32_16x16x32_bf16 v[156:159], v[220:223], v[140:143], v[156:159]
  s_waitcnt lgkmcnt(6)
  ds_read_b64_tr_b16 v[208:209], v250 offset:128
  ds_read_b64_tr_b16 v[210:211], v250 offset:1664
  v_mfma_f32_16x16x32_bf16 v[0:3], v[224:227], v[184:187], v[0:3]
  v_exp_f32 v244, v144
  v_mfma_f32_16x16x32_bf16 v[4:7], v[224:227], v[188:191], v[4:7]
  s_waitcnt lgkmcnt(6)
  ds_read_b64_tr_b16 v[212:213], v250 offset:160
  ds_read_b64_tr_b16 v[214:215], v250 offset:1696
  v_mfma_f32_16x16x32_bf16 v[8:11], v[228:231], v[184:187], v[8:11]
  v_exp_f32 v245, v145
  v_mfma_f32_16x16x32_bf16 v[12:15], v[228:231], v[188:191], v[12:15]
  s_waitcnt lgkmcnt(6)
  ds_read_b64_tr_b16 v[216:217], v250 offset:192
  ds_read_b64_tr_b16 v[218:219], v250 offset:1728
  v_mfma_f32_16x16x32_bf16 v[16:19], v[232:235], v[184:187], v[16:19]
  v_exp_f32 v246, v146
  v_mfma_f32_16x16x32_bf16 v[20:23], v[232:235], v[188:191], v[20:23]
  s_waitcnt lgkmcnt(6)
  ds_read_b64_tr_b16 v[220:221], v250 offset:224
  ds_read_b64_tr_b16 v[222:223], v250 offset:1760
  v_mfma_f32_16x16x32_bf16 v[24:27], v[236:239], v[184:187], v[24:27]
  v_exp_f32 v247, v147
  v_mfma_f32_16x16x32_bf16 v[28:31], v[236:239], v[188:191], v[28:31]
  s_waitcnt lgkmcnt(6)
  ds_read_b64_tr_b16 v[224:225], v250 offset:256
  ds_read_b64_tr_b16 v[226:227], v250 offset:1792
  v_mfma_f32_16x16x32_bf16 v[32:35], v[208:211], v[184:187], v[32:35]
  v_exp_f32 v205, v148
  v_mfma_f32_16x16x32_bf16 v[36:39], v[208:211], v[188:191], v[36:39]
  s_waitcnt lgkmcnt(6)
  ds_read_b64_tr_b16 v[228:229], v250 offset:288
  v_cvt_pk_bf16_f32 v176, v244, v245
  v_mfma_f32_16x16x32_bf16 v[40:43], v[212:215], v[184:187], v[40:43]
  ds_read_b64_tr_b16 v[230:231], v250 offset:1824
  v_cvt_pk_bf16_f32 v177, v246, v247
  v_mfma_f32_16x16x32_bf16 v[44:47], v[212:215], v[188:191], v[44:47]
  s_waitcnt lgkmcnt(6)
  ds_read_b64_tr_b16 v[232:233], v250 offset:320
  v_add_u32 v252, 12416, v250
  v_mfma_f32_16x16x32_bf16 v[48:51], v[216:219], v[184:187], v[48:51]
  ds_read_b64_tr_b16 v[234:235], v250 offset:1856
  v_add_u32 v253, 0xffff3e00, v250
  v_mfma_f32_16x16x32_bf16 v[52:55], v[216:219], v[188:191], v[52:55]
  s_waitcnt lgkmcnt(6)
  v_exp_f32 v206, v149
  v_smfmac_f32_16x16x64_bf16 v[200:203], v[240:243], v[184:191], v204
  s_barrier
  v_mfma_f32_16x16x32_bf16 v[56:59], v[220:223], v[184:187], v[56:59]
  ds_read_b64_tr_b16 v[236:237], v250 offset:352
  ds_read_b64_tr_b16 v[238:239], v250 offset:1888
  v_mfma_f32_16x16x32_bf16 v[60:63], v[220:223], v[188:191], v[60:63]
  s_waitcnt lgkmcnt(6)
  ds_read_b128 v[208:211], v248 offset:0
  v_min_u32 v250, v252, v253
  v_mfma_f32_16x16x32_bf16 v[64:67], v[224:227], v[184:187], v[64:67]
  ds_read_b128 v[212:215], v248 offset:64
  v_cvt_pk_bf16_f32 v180, v205, v206
  v_mfma_f32_16x16x32_bf16 v[68:71], v[224:227], v[188:191], v[68:71]
  s_waitcnt lgkmcnt(6)
  ds_read_b128 v[216:219], v248 offset:128
  v_mfma_f32_16x16x32_bf16 v[72:75], v[228:231], v[184:187], v[72:75]
  ds_read_b128 v[220:223], v248 offset:192
  v_or3_b32 v251, v176, v177, v180
  v_mfma_f32_16x16x32_bf16 v[76:79], v[228:231], v[188:191], v[76:79]
  s_waitcnt lgkmcnt(6)
  ds_read_b128 v[224:227], v248 offset:256
  v_mfma_f32_16x16x32_bf16 v[80:83], v[232:235], v[184:187], v[80:83]
  s_sub_u32 s55, s55, 1
  ds_read_b128 v[228:231], v248 offset:320
  v_mfma_f32_16x16x32_bf16 v[84:87], v[232:235], v[188:191], v[84:87]
  s_waitcnt lgkmcnt(6)
  ds_read_b128 v[232:235], v248 offset:1536
  v_mfma_f32_16x16x32_bf16 v[88:91], v[236:239], v[184:187], v[88:91]
  s_waitcnt lgkmcnt(6)
  v_exp_f32 v244, v150
  v_mfma_f32_16x16x32_bf16 v[92:95], v[236:239], v[188:191], v[92:95]
  s_cbranch_scc0 L_step0b
  s_branch L_ev0
.p2align 6
L_step0:
  v_mfma_f32_16x16x32_bf16 v[160:163], v[208:211], v[96:99], v[192:195]
  s_waitcnt lgkmcnt(5)
  ds_read_b128 v[236:239], v248 offset:1600
  v_mfma_f32_16x16x32_bf16 v[160:163], v[212:215], v[100:103], v[160:163]
  s_waitcnt lgkmcnt(5)
  v_exp_f32 v245, v151
  v_mfma_f32_16x16x32_bf16 v[160:163], v[216:219], v[104:107], v[160:163]
  s_waitcnt lgkmcnt(4)
  v_exp_f32 v246, v152
  v_mfma_f32_16x16x32_bf16 v[160:163], v[220:223], v[108:111], v[160:163]
  s_waitcnt lgkmcnt(3)
  v_exp_f32 v247, v153
  v_mfma_f32_16x16x32_bf16 v[160:163], v[224:227], v[112:115], v[160:163]
  s_waitcnt lgkmcnt(2)
  v_exp_f32 v205, v154
  v_mfma_f32_16x16x32_bf16 v[160:163], v[228:231], v[116:119], v[160:163]
  v_exp_f32 v206, v155
  v_mfma_f32_16x16x32_bf16 v[164:167], v[208:211], v[120:123], v[196:199]
  ds_read_b128 v[208:211], v248 offset:1664
  v_cvt_pk_bf16_f32 v181, v244, v245
  v_mfma_f32_16x16x32_bf16 v[164:167], v[212:215], v[124:127], v[164:167]
  ds_read_b128 v[212:215], v248 offset:1728
  v_cvt_pk_bf16_f32 v178, v246, v247
  v_mfma_f32_16x16x32_bf16 v[164:167], v[216:219], v[128:131], v[164:167]
  ds_read_b128 v[216:219], v248 offset:1792
  v_cvt_pk_bf16_f32 v179, v205, v206
  v_mfma_f32_16x16x32_bf16 v[164:167], v[220:223], v[132:135], v[164:167]
  ds_read_b128 v[220:223], v248 offset:1856
  v_or3_b32 v251, v251, v181, v178
  v_mfma_f32_16x16x32_bf16 v[164:167], v[224:227], v[136:139], v[164:167]
  ds_read_b64_tr_b16 v[224:225], v250 offset:0
  v_mfma_f32_16x16x32_bf16 v[164:167], v[228:231], v[140:143], v[164:167]
  s_waitcnt lgkmcnt(6)
  ds_read_b64_tr_b16 v[226:227], v250 offset:1536
  v_mfma_f32_16x16x32_bf16 v[168:171], v[232:235], v[96:99], v[192:195]
  s_waitcnt lgkmcnt(6)
  v_exp_f32 v244, v156
  v_mfma_f32_16x16x32_bf16 v[168:171], v[236:239], v[100:103], v[168:171]
  s_waitcnt lgkmcnt(5)
  v_exp_f32 v245, v157
  v_mfma_f32_16x16x32_bf16 v[168:171], v[208:211], v[104:107], v[168:171]
  s_waitcnt lgkmcnt(4)
  v_exp_f32 v246, v158
  v_mfma_f32_16x16x32_bf16 v[168:171], v[212:215], v[108:111], v[168:171]
  s_waitcnt lgkmcnt(3)
  v_exp_f32 v247, v159
  v_mfma_f32_16x16x32_bf16 v[168:171], v[216:219], v[112:115], v[168:171]
  s_waitcnt lgkmcnt(2)
  ds_read_b64_tr_b16 v[228:229], v250 offset:32
  v_cvt_pk_bf16_f32 v182, v244, v245
  v_mfma_f32_16x16x32_bf16 v[168:171], v[220:223], v[116:119], v[168:171]
  ds_read_b64_tr_b16 v[230:231], v250 offset:1568
  v_cvt_pk_bf16_f32 v183, v246, v247
  v_mfma_f32_16x16x32_bf16 v[172:175], v[232:235], v[120:123], v[196:199]
  ds_read_b64_tr_b16 v[232:233], v250 offset:64
  v_or3_b32 v251, v251, v179, v182
  v_mfma_f32_16x16x32_bf16 v[172:175], v[236:239], v[124:127], v[172:175]
  ds_read_b64_tr_b16 v[234:235], v250 offset:1600
  v_bitop3_b32 v251, v251, v183, s57 bitop3:0xa8
  v_mfma_f32_16x16x32_bf16 v[172:175], v[208:211], v[128:131], v[172:175]
  ds_read_b64_tr_b16 v[236:237], v250 offset:96
  v_cmp_ne_u32 vcc, 0, v251
  v_mfma_f32_16x16x32_bf16 v[172:175], v[212:215], v[132:135], v[172:175]
  ds_read_b64_tr_b16 v[238:239], v250 offset:1632
  v_mfma_f32_16x16x32_bf16 v[172:175], v[216:219], v[136:139], v[172:175]
  s_cbranch_vccnz L_stub2
L_chkret2:
  v_mfma_f32_16x16x32_bf16 v[172:175], v[220:223], v[140:143], v[172:175]
  s_waitcnt lgkmcnt(6)
  ds_read_b64_tr_b16 v[208:209], v250 offset:128
  ds_read_b64_tr_b16 v[210:211], v250 offset:1664
  v_mfma_f32_16x16x32_bf16 v[0:3], v[224:227], v[176:179], v[0:3]
  v_exp_f32 v244, v160
  v_mfma_f32_16x16x32_bf16 v[4:7], v[224:227], v[180:183], v[4:7]
  s_waitcnt lgkmcnt(6)
  ds_read_b64_tr_b16 v[212:213], v250 offset:160
  ds_read_b64_tr_b16 v[214:215], v250 offset:1696
  v_mfma_f32_16x16x32_bf16 v[8:11], v[228:231], v[176:179], v[8:11]
  v_exp_f32 v245, v161
  v_mfma_f32_16x16x32_bf16 v[12:15], v[228:231], v[180:183], v[12:15]
  s_waitcnt lgkmcnt(6)
  ds_read_b64_tr_b16 v[216:217], v250 offset:192
  ds_read_b64_tr_b16 v[218:219], v250 offset:1728
  v_mfma_f32_16x16x32_bf16 v[16:19], v[232:235], v[176:179], v[16:19]
  v_exp_f32 v246, v162
  v_mfma_f32_16x16x32_bf16 v[20:23], v[232:235], v[180:183], v[20:23]
  s_waitcnt lgkmcnt(6)
  ds_read_b64_tr_b16 v[220:221], v250 offset:224
  ds_read_b64_tr_b16 v[222:223], v250 offset:1760
  v_mfma_f32_16x16x32_bf16 v[24:27], v[236:239], v[176:179], v[24:27]
  v_exp_f32 v247, v163
  v_mfma_f32_16x16x32_bf16 v[28:31], v[236:239], v[180:183], v[28:31]
  s_waitcnt lgkmcnt(6)
  ds_read_b64_tr_b16 v[224:225], v250 offset:256
  ds_read_b64_tr_b16 v[226:227], v250 offset:1792
  v_mfma_f32_16x16x32_bf16 v[32:35], v[208:211], v[176:179], v[32:35]
  v_exp_f32 v205, v164
  v_mfma_f32_16x16x32_bf16 v[36:39], v[208:211], v[180:183], v[36:39]
  s_waitcnt lgkmcnt(6)
  ds_read_b64_tr_b16 v[228:229], v250 offset:288
  v_cvt_pk_bf16_f32 v184, v244, v245
  v_mfma_f32_16x16x32_bf16 v[40:43], v[212:215], v[176:179], v[40:43]
  ds_read_b64_tr_b16 v[230:231], v250 offset:1824
  v_cvt_pk_bf16_f32 v185, v246, v247
  v_mfma_f32_16x16x32_bf16 v[44:47], v[212:215], v[180:183], v[44:47]
  s_waitcnt lgkmcnt(6)
  ds_read_b64_tr_b16 v[232:233], v250 offset:320
  v_add_u32 v252, 12416, v250
  v_mfma_f32_16x16x32_bf16 v[48:51], v[216:219], v[176:179], v[48:51]
  ds_read_b64_tr_b16 v[234:235], v250 offset:1856
  v_add_u32 v253, 0xffff3e00, v250
  v_mfma_f32_16x16x32_bf16 v[52:55], v[216:219], v[180:183], v[52:55]
  s_waitcnt lgkmcnt(6)
  v_exp_f32 v206, v165
  v_mfma_f32_16x16x32_bf16 v[56:59], v[220:223], v[176:179], v[56:59]
  ds_read_b64_tr_b16 v[236:237], v250 offset:352
  ds_read_b64_tr_b16 v[238:239], v250 offset:1888
  v_smfmac_f32_16x16x64_bf16 v[200:203], v[240:243], v[176:183], v204
  s_barrier
  v_mfma_f32_16x16x32_bf16 v[60:63], v[220:223], v[180:183], v[60:63]
  s_waitcnt lgkmcnt(6)
  ds_read_b128 v[208:211], v248 offset:12416
  v_min_u32 v250, v252, v253
  v_mfma_f32_16x16x32_bf16 v[64:67], v[224:227], v[176:179], v[64:67]
  ds_read_b128 v[212:215], v248 offset:12480
  v_cvt_pk_bf16_f32 v188, v205, v206
  v_mfma_f32_16x16x32_bf16 v[68:71], v[224:227], v[180:183], v[68:71]
  s_waitcnt lgkmcnt(6)
  ds_read_b128 v[216:219], v248 offset:12544
  v_mfma_f32_16x16x32_bf16 v[72:75], v[228:231], v[176:179], v[72:75]
  ds_read_b128 v[220:223], v248 offset:12608
  v_or3_b32 v251, v184, v185, v188
  v_mfma_f32_16x16x32_bf16 v[76:79], v[228:231], v[180:183], v[76:79]
  s_waitcnt lgkmcnt(6)
  ds_read_b128 v[224:227], v248 offset:12672
  v_mfma_f32_16x16x32_bf16 v[80:83], v[232:235], v[176:179], v[80:83]
  s_sub_u32 s55, s55, 1
  ds_read_b128 v[228:231], v248 offset:12736
  v_mfma_f32_16x16x32_bf16 v[84:87], v[232:235], v[180:183], v[84:87]
  s_waitcnt lgkmcnt(6)
  ds_read_b128 v[232:235], v248 offset:13952
  v_mfma_f32_16x16x32_bf16 v[88:91], v[236:239], v[176:179], v[88:91]
  s_waitcnt lgkmcnt(6)
  v_exp_f32 v244, v166
  v_mfma_f32_16x16x32_bf16 v[92:95], v[236:239], v[180:183], v[92:95]
  s_cbranch_scc1 L_ev1
L_step1:
  v_mfma_f32_16x16x32_bf16 v[144:147], v[208:211], v[96:99], v[192:195]
  s_waitcnt lgkmcnt(5)
  ds_read_b128 v[236:239], v248 offset:14016
  v_mfma_f32_16x16x32_bf16 v[144:147], v[212:215], v[100:103], v[144:147]
  s_waitcnt lgkmcnt(5)
  v_exp_f32 v245, v167
  v_mfma_f32_16x16x32_bf16 v[144:147], v[216:219], v[104:107], v[144:147]
  s_waitcnt lgkmcnt(4)
  v_exp_f32 v246, v168
  v_mfma_f32_16x16x32_bf16 v[144:147], v[220:223], v[108:111], v[144:147]
  s_waitcnt lgkmcnt(3)
  v_exp_f32 v247, v169
  v_mfma_f32_16x16x32_bf16 v[144:147], v[224:227], v[112:115], v[144:147]
  s_waitcnt lgkmcnt(2)
  v_exp_f32 v205, v170
  v_mfma_f32_16x16x32_bf16 v[144:147], v[228:231], v[116:119], v[144:147]
  v_exp_f32 v206, v171
  v_mfma_f32_16x16x32_bf16 v[148:151], v[208:211], v[120:123], v[196:199]
  ds_read_b128 v[208:211], v248 offset:14080
  v_cvt_pk_bf16_f32 v189, v244, v245
  v_mfma_f32_16x16x32_bf16 v[148:151], v[212:215], v[124:127], v[148:151]
  ds_read_b128 v[212:215], v248 offset:14144
  v_cvt_pk_bf16_f32 v186, v246, v247
  v_mfma_f32_16x16x32_bf16 v[148:151], v[216:219], v[128:131], v[148:151]
  ds_read_b128 v[216:219], v248 offset:14208
  v_cvt_pk_bf16_f32 v187, v205, v206
  v_mfma_f32_16x16x32_bf16 v[148:151], v[220:223], v[132:135], v[148:151]
  ds_read_b128 v[220:223], v248 offset:14272
  v_or3_b32 v251, v251, v189, v186
  v_mfma_f32_16x16x32_bf16 v[148:151], v[224:227], v[136:139], v[148:151]
  ds_read_b64_tr_b16 v[224:225], v250 offset:0
  v_mfma_f32_16x16x32_bf16 v[148:151], v[228:231], v[140:143], v[148:151]
  s_waitcnt lgkmcnt(6)
  ds_read_b64_tr_b16 v[226:227], v250 offset:1536
  v_swap_b32 v248, v249
  v_mfma_f32_16x16x32_bf16 v[152:155], v[232:235], v[96:99], v[192:195]
  s_waitcnt lgkmcnt(6)
  v_exp_f32 v244, v172
  v_mfma_f32_16x16x32_bf16 v[152:155], v[236:239], v[100:103], v[152:155]
  s_waitcnt lgkmcnt(5)
  v_exp_f32 v245, v173
  v_mfma_f32_16x16x32_bf16 v[152:155], v[208:211], v[104:107], v[152:155]
  s_waitcnt lgkmcnt(4)
  v_exp_f32 v246, v174
  v_mfma_f32_16x16x32_bf16 v[152:155], v[212:215], v[108:111], v[152:155]
  s_waitcnt lgkmcnt(3)
  v_exp_f32 v247, v175
  v_mfma_f32_16x16x32_bf16 v[152:155], v[216:219], v[112:115], v[152:155]
  s_waitcnt lgkmcnt(2)
  ds_read_b64_tr_b16 v[228:229], v250 offset:32
  v_cvt_pk_bf16_f32 v190, v244, v245
  v_mfma_f32_16x16x32_bf16 v[152:155], v[220:223], v[116:119], v[152:155]
  ds_read_b64_tr_b16 v[230:231], v250 offset:1568
  v_cvt_pk_bf16_f32 v191, v246, v247
  v_mfma_f32_16x16x32_bf16 v[156:159], v[232:235], v[120:123], v[196:199]
  ds_read_b64_tr_b16 v[232:233], v250 offset:64
  v_or3_b32 v251, v251, v187, v190
  v_mfma_f32_16x16x32_bf16 v[156:159], v[236:239], v[124:127], v[156:159]
  ds_read_b64_tr_b16 v[234:235], v250 offset:1600
  v_bitop3_b32 v251, v251, v191, s57 bitop3:0xa8
  v_mfma_f32_16x16x32_bf16 v[156:159], v[208:211], v[128:131], v[156:159]
  ds_read_b64_tr_b16 v[236:237], v250 offset:96
  v_cmp_ne_u32 vcc, 0, v251
  v_mfma_f32_16x16x32_bf16 v[156:159], v[212:215], v[132:135], v[156:159]
  ds_read_b64_tr_b16 v[238:239], v250 offset:1632
  v_mfma_f32_16x16x32_bf16 v[156:159], v[216:219], v[136:139], v[156:159]
  s_cbranch_vccnz L_stub3
L_chkret3:
  v_mfma_f32_16x16x32_bf16 v[156:159], v[220:223], v[140:143], v[156:159]
  s_waitcnt lgkmcnt(6)
  ds_read_b64_tr_b16 v[208:209], v250 offset:128
  ds_read_b64_tr_b16 v[210:211], v250 offset:1664
  v_mfma_f32_16x16x32_bf16 v[0:3], v[224:227], v[184:187], v[0:3]
  v_exp_f32 v244, v144
  v_mfma_f32_16x16x32_bf16 v[4:7], v[224:227], v[188:191], v[4:7]
  s_waitcnt lgkmcnt(6)
  ds_read_b64_tr_b16 v[212:213], v250 offset:160
  ds_read_b64_tr_b16 v[214:215], v250 offset:1696
  v_mfma_f32_16x16x32_bf16 v[8:11], v[228:231], v[184:187], v[8:11]
  v_exp_f32 v245, v145
  v_mfma_f32_16x16x32_bf16 v[12:15], v[228:231], v[188:191], v[12:15]
  s_waitcnt lgkmcnt(6)
  ds_read_b64_tr_b16 v[216:217], v250 offset:192
  ds_read_b64_tr_b16 v[218:219], v250 offset:1728
  v_mfma_f32_16x16x32_bf16 v[16:19], v[232:235], v[184:187], v[16:19]
  v_exp_f32 v246, v146
  v_mfma_f32_16x16x32_bf16 v[20:23], v[232:235], v[188:191], v[20:23]
  s_waitcnt lgkmcnt(6)
  ds_read_b64_tr_b16 v[220:221], v250 offset:224
  ds_read_b64_tr_b16 v[222:223], v250 offset:1760
  v_mfma_f32_16x16x32_bf16 v[24:27], v[236:239], v[184:187], v[24:27]
  v_exp_f32 v247, v147
  v_mfma_f32_16x16x32_bf16 v[28:31], v[236:239], v[188:191], v[28:31]
  s_waitcnt lgkmcnt(6)
  ds_read_b64_tr_b16 v[224:225], v250 offset:256
  ds_read_b64_tr_b16 v[226:227], v250 offset:1792
  v_mfma_f32_16x16x32_bf16 v[32:35], v[208:211], v[184:187], v[32:35]
  v_exp_f32 v205, v148
  v_mfma_f32_16x16x32_bf16 v[36:39], v[208:211], v[188:191], v[36:39]
  s_waitcnt lgkmcnt(6)
  ds_read_b64_tr_b16 v[228:229], v250 offset:288
  v_cvt_pk_bf16_f32 v176, v244, v245
  v_mfma_f32_16x16x32_bf16 v[40:43], v[212:215], v[184:187], v[40:43]
  ds_read_b64_tr_b16 v[230:231], v250 offset:1824
  v_cvt_pk_bf16_f32 v177, v246, v247
  v_mfma_f32_16x16x32_bf16 v[44:47], v[212:215], v[188:191], v[44:47]
  s_waitcnt lgkmcnt(6)
  ds_read_b64_tr_b16 v[232:233], v250 offset:320
  v_add_u32 v252, 12416, v250
  v_mfma_f32_16x16x32_bf16 v[48:51], v[216:219], v[184:187], v[48:51]
  ds_read_b64_tr_b16 v[234:235], v250 offset:1856
  v_add_u32 v253, 0xffff3e00, v250
  v_mfma_f32_16x16x32_bf16 v[52:55], v[216:219], v[188:191], v[52:55]
  s_waitcnt lgkmcnt(6)
  v_exp_f32 v206, v149
  v_mfma_f32_16x16x32_bf16 v[56:59], v[220:223], v[184:187], v[56:59]
  ds_read_b64_tr_b16 v[236:237], v250 offset:352
  ds_read_b64_tr_b16 v[238:239], v250 offset:1888
  v_smfmac_f32_16x16x64_bf16 v[200:203], v[240:243], v[184:191], v204
  s_barrier
  v_mfma_f32_16x16x32_bf16 v[60:63], v[220:223], v[188:191], v[60:63]
  s_waitcnt lgkmcnt(6)
  ds_read_b128 v[208:211], v248 offset:0
  v_min_u32 v250, v252, v253
  v_mfma_f32_16x16x32_bf16 v[64:67], v[224:227], v[184:187], v[64:67]
  ds_read_b128 v[212:215], v248 offset:64
  v_cvt_pk_bf16_f32 v180, v205, v206
  v_mfma_f32_16x16x32_bf16 v[68:71], v[224:227], v[188:191], v[68:71]
  s_waitcnt lgkmcnt(6)
  ds_read_b128 v[216:219], v248 offset:128
  v_mfma_f32_16x16x32_bf16 v[72:75], v[228:231], v[184:187], v[72:75]
  ds_read_b128 v[220:223], v248 offset:192
  v_or3_b32 v251, v176, v177, v180
  v_mfma_f32_16x16x32_bf16 v[76:79], v[228:231], v[188:191], v[76:79]
  s_waitcnt lgkmcnt(6)
  ds_read_b128 v[224:227], v248 offset:256
  v_mfma_f32_16x16x32_bf16 v[80:83], v[232:235], v[184:187], v[80:83]
  s_sub_u32 s55, s55, 1
  ds_read_b128 v[228:231], v248 offset:320
  v_mfma_f32_16x16x32_bf16 v[84:87], v[232:235], v[188:191], v[84:87]
  s_waitcnt lgkmcnt(6)
  ds_read_b128 v[232:235], v248 offset:1536
  v_mfma_f32_16x16x32_bf16 v[88:91], v[236:239], v[184:187], v[88:91]
  s_waitcnt lgkmcnt(6)
  v_exp_f32 v244, v150
  v_mfma_f32_16x16x32_bf16 v[92:95], v[236:239], v[188:191], v[92:95]
  s_cbranch_scc0 L_step0
L_ev0:
  v_mfma_f32_16x16x32_bf16 v[160:163], v[208:211], v[96:99], v[192:195]
  s_waitcnt lgkmcnt(5)
  ds_read_b128 v[236:239], v248 offset:1600
  v_mfma_f32_16x16x32_bf16 v[160:163], v[212:215], v[100:103], v[160:163]
  s_waitcnt lgkmcnt(5)
  v_exp_f32 v245, v151
  v_mfma_f32_16x16x32_bf16 v[160:163], v[216:219], v[104:107], v[160:163]
  s_waitcnt lgkmcnt(4)
  v_exp_f32 v246, v152
  v_mfma_f32_16x16x32_bf16 v[160:163], v[220:223], v[108:111], v[160:163]
  s_waitcnt lgkmcnt(3)
  v_exp_f32 v247, v153
  v_mfma_f32_16x16x32_bf16 v[160:163], v[224:227], v[112:115], v[160:163]
  s_waitcnt lgkmcnt(2)
  v_exp_f32 v205, v154
  v_mfma_f32_16x16x32_bf16 v[160:163], v[228:231], v[116:119], v[160:163]
  v_exp_f32 v206, v155
  v_mfma_f32_16x16x32_bf16 v[164:167], v[208:211], v[120:123], v[196:199]
  ds_read_b128 v[208:211], v248 offset:1664
  v_cvt_pk_bf16_f32 v181, v244, v245
  v_mfma_f32_16x16x32_bf16 v[164:167], v[212:215], v[124:127], v[164:167]
  ds_read_b128 v[212:215], v248 offset:1728
  v_cvt_pk_bf16_f32 v178, v246, v247
  v_mfma_f32_16x16x32_bf16 v[164:167], v[216:219], v[128:131], v[164:167]
  ds_read_b128 v[216:219], v248 offset:1792
  v_cvt_pk_bf16_f32 v179, v205, v206
  v_mfma_f32_16x16x32_bf16 v[164:167], v[220:223], v[132:135], v[164:167]
  ds_read_b128 v[220:223], v248 offset:1856
  v_or3_b32 v251, v251, v181, v178
  v_mfma_f32_16x16x32_bf16 v[164:167], v[224:227], v[136:139], v[164:167]
  ds_read_b64_tr_b16 v[224:225], v250 offset:0
  v_mfma_f32_16x16x32_bf16 v[164:167], v[228:231], v[140:143], v[164:167]
  s_waitcnt lgkmcnt(6)
  ds_read_b64_tr_b16 v[226:227], v250 offset:1536
  v_mfma_f32_16x16x32_bf16 v[168:171], v[232:235], v[96:99], v[192:195]
  s_waitcnt lgkmcnt(6)
  v_exp_f32 v244, v156
  v_mfma_f32_16x16x32_bf16 v[168:171], v[236:239], v[100:103], v[168:171]
  s_waitcnt lgkmcnt(5)
  v_exp_f32 v245, v157
  v_mfma_f32_16x16x32_bf16 v[168:171], v[208:211], v[104:107], v[168:171]
  s_waitcnt lgkmcnt(4)
  v_exp_f32 v246, v158
  v_mfma_f32_16x16x32_bf16 v[168:171], v[212:215], v[108:111], v[168:171]
  s_waitcnt lgkmcnt(3)
  v_exp_f32 v247, v159
  v_mfma_f32_16x16x32_bf16 v[168:171], v[216:219], v[112:115], v[168:171]
  s_waitcnt lgkmcnt(2)
  ds_read_b64_tr_b16 v[228:229], v250 offset:32
  v_cvt_pk_bf16_f32 v182, v244, v245
  v_mfma_f32_16x16x32_bf16 v[168:171], v[220:223], v[116:119], v[168:171]
  ds_read_b64_tr_b16 v[230:231], v250 offset:1568
  v_cvt_pk_bf16_f32 v183, v246, v247
  v_mfma_f32_16x16x32_bf16 v[172:175], v[232:235], v[120:123], v[196:199]
  ds_read_b64_tr_b16 v[232:233], v250 offset:64
  v_or3_b32 v251, v251, v179, v182
  v_mfma_f32_16x16x32_bf16 v[172:175], v[236:239], v[124:127], v[172:175]
  ds_read_b64_tr_b16 v[234:235], v250 offset:1600
  v_bitop3_b32 v251, v251, v183, s57 bitop3:0xa8
  v_mfma_f32_16x16x32_bf16 v[172:175], v[208:211], v[128:131], v[172:175]
  ds_read_b64_tr_b16 v[236:237], v250 offset:96
  v_cmp_ne_u32 vcc, 0, v251
  v_mfma_f32_16x16x32_bf16 v[172:175], v[212:215], v[132:135], v[172:175]
  ds_read_b64_tr_b16 v[238:239], v250 offset:1632
  v_mfma_f32_16x16x32_bf16 v[172:175], v[216:219], v[136:139], v[172:175]
  s_cbranch_vccnz L_stub4
L_chkret4:
  v_mfma_f32_16x16x32_bf16 v[172:175], v[220:223], v[140:143], v[172:175]
  s_waitcnt lgkmcnt(6)
  ds_read_b64_tr_b16 v[208:209], v250 offset:128
  ds_read_b64_tr_b16 v[210:211], v250 offset:1664
  v_mfma_f32_16x16x32_bf16 v[0:3], v[224:227], v[176:179], v[0:3]
  v_mfma_f32_16x16x32_bf16 v[4:7], v[224:227], v[180:183], v[4:7]
  s_waitcnt lgkmcnt(6)
  ds_read_b64_tr_b16 v[212:213], v250 offset:160
  ds_read_b64_tr_b16 v[214:215], v250 offset:1696
  v_mfma_f32_16x16x32_bf16 v[8:11], v[228:231], v[176:179], v[8:11]
  v_mfma_f32_16x16x32_bf16 v[12:15], v[228:231], v[180:183], v[12:15]
  s_waitcnt lgkmcnt(6)
  ds_read_b64_tr_b16 v[216:217], v250 offset:192
  ds_read_b64_tr_b16 v[218:219], v250 offset:1728
  v_mfma_f32_16x16x32_bf16 v[16:19], v[232:235], v[176:179], v[16:19]
  v_mfma_f32_16x16x32_bf16 v[20:23], v[232:235], v[180:183], v[20:23]
  s_waitcnt lgkmcnt(6)
  ds_read_b64_tr_b16 v[220:221], v250 offset:224
  ds_read_b64_tr_b16 v[222:223], v250 offset:1760
  v_mfma_f32_16x16x32_bf16 v[24:27], v[236:239], v[176:179], v[24:27]
  v_mfma_f32_16x16x32_bf16 v[28:31], v[236:239], v[180:183], v[28:31]
  s_waitcnt lgkmcnt(6)
  ds_read_b64_tr_b16 v[224:225], v250 offset:256
  ds_read_b64_tr_b16 v[226:227], v250 offset:1792
  v_mfma_f32_16x16x32_bf16 v[32:35], v[208:211], v[176:179], v[32:35]
  v_mfma_f32_16x16x32_bf16 v[36:39], v[208:211], v[180:183], v[36:39]
  s_waitcnt lgkmcnt(6)
  ds_read_b64_tr_b16 v[228:229], v250 offset:288
  v_mfma_f32_16x16x32_bf16 v[40:43], v[212:215], v[176:179], v[40:43]
  ds_read_b64_tr_b16 v[230:231], v250 offset:1824
  v_mfma_f32_16x16x32_bf16 v[44:47], v[212:215], v[180:183], v[44:47]
  s_waitcnt lgkmcnt(6)
  ds_read_b64_tr_b16 v[232:233], v250 offset:320
  v_add_u32 v252, 12416, v250
  v_mfma_f32_16x16x32_bf16 v[48:51], v[216:219], v[176:179], v[48:51]
  ds_read_b64_tr_b16 v[234:235], v250 offset:1856
  v_add_u32 v253, 0xffff3e00, v250
  v_mfma_f32_16x16x32_bf16 v[52:55], v[216:219], v[180:183], v[52:55]
  s_waitcnt lgkmcnt(6)
  v_mfma_f32_16x16x32_bf16 v[56:59], v[220:223], v[176:179], v[56:59]
  ds_read_b64_tr_b16 v[236:237], v250 offset:352
  ds_read_b64_tr_b16 v[238:239], v250 offset:1888
  v_smfmac_f32_16x16x64_bf16 v[200:203], v[240:243], v[176:183], v204
  s_barrier
  v_mfma_f32_16x16x32_bf16 v[60:63], v[220:223], v[180:183], v[60:63]
  s_waitcnt lgkmcnt(6)
  ds_read_b128 v[208:211], v248 offset:12416
  v_min_u32 v250, v252, v253
  v_mfma_f32_16x16x32_bf16 v[64:67], v[224:227], v[176:179], v[64:67]
  ds_read_b128 v[212:215], v248 offset:12480
  v_mfma_f32_16x16x32_bf16 v[68:71], v[224:227], v[180:183], v[68:71]
  s_waitcnt lgkmcnt(6)
  ds_read_b128 v[216:219], v248 offset:12544
  v_mfma_f32_16x16x32_bf16 v[72:75], v[228:231], v[176:179], v[72:75]
  ds_read_b128 v[220:223], v248 offset:12608
  v_mfma_f32_16x16x32_bf16 v[76:79], v[228:231], v[180:183], v[76:79]
  s_waitcnt lgkmcnt(6)
  ds_read_b128 v[224:227], v248 offset:12672
  v_mfma_f32_16x16x32_bf16 v[80:83], v[232:235], v[176:179], v[80:83]
  ds_read_b128 v[228:231], v248 offset:12736
  v_mfma_f32_16x16x32_bf16 v[84:87], v[232:235], v[180:183], v[84:87]
  s_waitcnt lgkmcnt(6)
  ds_read_b128 v[232:235], v248 offset:13952
  v_mfma_f32_16x16x32_bf16 v[88:91], v[236:239], v[176:179], v[88:91]
  s_waitcnt lgkmcnt(6)
  v_mfma_f32_16x16x32_bf16 v[92:95], v[236:239], v[180:183], v[92:95]
  ds_read_b64_tr_b16 v[208:209], v250 offset:0
  ds_read_b64_tr_b16 v[210:211], v250 offset:1536
  ds_read_b64_tr_b16 v[212:213], v250 offset:32
  ds_read_b64_tr_b16 v[214:215], v250 offset:1568
  ds_read_b64_tr_b16 v[216:217], v250 offset:64
  ds_read_b64_tr_b16 v[218:219], v250 offset:1600
  ds_read_b64_tr_b16 v[220:221], v250 offset:96
  ds_read_b64_tr_b16 v[222:223], v250 offset:1632
  ds_read_b64_tr_b16 v[224:225], v250 offset:128
  ds_read_b64_tr_b16 v[226:227], v250 offset:1664
  ds_read_b64_tr_b16 v[228:229], v250 offset:160
  ds_read_b64_tr_b16 v[230:231], v250 offset:1696
  ds_read_b64_tr_b16 v[232:233], v250 offset:192
  ds_read_b64_tr_b16 v[234:235], v250 offset:1728
  ds_read_b64_tr_b16 v[236:237], v250 offset:224
  ds_read_b64_tr_b16 v[238:239], v250 offset:1760
  v_mov_b32 v251, 0xff800000
  v_cndmask_b32 v160, v160, v251, s[64:65]
  v_cndmask_b32 v161, v161, v251, s[66:67]
  v_cndmask_b32 v162, v162, v251, s[68:69]
  v_cndmask_b32 v163, v163, v251, s[70:71]
  v_cndmask_b32 v164, v164, v251, s[72:73]
  v_cndmask_b32 v165, v165, v251, s[74:75]
  v_cndmask_b32 v166, v166, v251, s[76:77]
  v_cndmask_b32 v167, v167, v251, s[78:79]
  v_cndmask_b32 v168, v168, v251, s[80:81]
  v_cndmask_b32 v169, v169, v251, s[82:83]
  v_cndmask_b32 v170, v170, v251, s[84:85]
  v_cndmask_b32 v171, v171, v251, s[86:87]
  v_cndmask_b32 v172, v172, v251, s[88:89]
  v_cndmask_b32 v173, v173, v251, s[90:91]
  v_cndmask_b32 v174, v174, v251, s[92:93]
  v_cndmask_b32 v175, v175, v251, s[94:95]
  v_exp_f32 v244, v160
  v_exp_f32 v245, v161
  v_exp_f32 v246, v162
  v_exp_f32 v247, v163
  v_exp_f32 v205, v164
  v_cvt_pk_bf16_f32 v184, v244, v245
  v_cvt_pk_bf16_f32 v185, v246, v247
  v_exp_f32 v206, v165
  s_nop 0
  v_cvt_pk_bf16_f32 v188, v205, v206
  v_or3_b32 v251, v184, v185, v188
  v_exp_f32 v244, v166
  v_exp_f32 v245, v167
  v_exp_f32 v246, v168
  v_exp_f32 v247, v169
  v_exp_f32 v205, v170
  v_exp_f32 v206, v171
  v_cvt_pk_bf16_f32 v189, v244, v245
  v_cvt_pk_bf16_f32 v186, v246, v247
  v_cvt_pk_bf16_f32 v187, v205, v206
  v_or3_b32 v251, v251, v189, v186
  v_exp_f32 v244, v172
  v_exp_f32 v245, v173
  v_exp_f32 v246, v174
  v_exp_f32 v247, v175
  v_cvt_pk_bf16_f32 v190, v244, v245
  v_cvt_pk_bf16_f32 v191, v246, v247
  v_or3_b32 v251, v251, v187, v190
  v_bitop3_b32 v251, v251, v191, s57 bitop3:0xa8
  v_cmp_ne_u32 vcc, 0, v251
  s_waitcnt lgkmcnt(14)
  s_cbranch_vccnz L_stub5
L_chkret5:
  v_smfmac_f32_16x16x64_bf16 v[200:203], v[240:243], v[184:191], v204
  v_mfma_f32_16x16x32_bf16 v[0:3], v[208:211], v[184:187], v[0:3]
  v_min_u32 v252, v248, v249
  v_add_u32 v252, s99, v252
  v_mfma_f32_16x16x32_bf16 v[4:7], v[208:211], v[188:191], v[4:7]
  s_waitcnt lgkmcnt(12)
  ds_read_b64_tr_b16 v[208:209], v250 offset:256
  ds_read_b64_tr_b16 v[210:211], v250 offset:1792
  v_mfma_f32_16x16x32_bf16 v[8:11], v[212:215], v[184:187], v[8:11]
  ds_read_b128 v[96:99], v252 offset:50304
  ds_read_b128 v[100:103], v252 offset:50368
  v_mfma_f32_16x16x32_bf16 v[12:15], v[212:215], v[188:191], v[12:15]
  s_waitcnt lgkmcnt(14)
  ds_read_b64_tr_b16 v[212:213], v250 offset:288
  ds_read_b64_tr_b16 v[214:215], v250 offset:1824
  v_mfma_f32_16x16x32_bf16 v[16:19], v[216:219], v[184:187], v[16:19]
  ds_read_b128 v[104:107], v252 offset:50432
  ds_read_b128 v[108:111], v252 offset:50496
  v_mfma_f32_16x16x32_bf16 v[20:23], v[216:219], v[188:191], v[20:23]
  s_waitcnt lgkmcnt(14)
  ds_read_b64_tr_b16 v[216:217], v250 offset:320
  ds_read_b64_tr_b16 v[218:219], v250 offset:1856
  v_mfma_f32_16x16x32_bf16 v[24:27], v[220:223], v[184:187], v[24:27]
  ds_read_b128 v[112:115], v252 offset:50560
  ds_read_b128 v[116:119], v252 offset:50624
  v_mfma_f32_16x16x32_bf16 v[28:31], v[220:223], v[188:191], v[28:31]
  s_waitcnt lgkmcnt(14)
  ds_read_b64_tr_b16 v[220:221], v250 offset:352
  ds_read_b64_tr_b16 v[222:223], v250 offset:1888
  v_mfma_f32_16x16x32_bf16 v[32:35], v[224:227], v[184:187], v[32:35]
  ds_read_b128 v[120:123], v252 offset:51840
  ds_read_b128 v[124:127], v252 offset:51904
  v_mfma_f32_16x16x32_bf16 v[36:39], v[224:227], v[188:191], v[36:39]
  s_waitcnt lgkmcnt(14)
  ds_read_b128 v[128:131], v252 offset:51968
  ds_read_b128 v[132:135], v252 offset:52032
  v_mfma_f32_16x16x32_bf16 v[40:43], v[228:231], v[184:187], v[40:43]
  ds_read_b128 v[136:139], v252 offset:52096
  ds_read_b128 v[140:143], v252 offset:52160
  v_mfma_f32_16x16x32_bf16 v[44:47], v[228:231], v[188:191], v[44:47]
  s_waitcnt lgkmcnt(14)
  v_add_f32 v244, v200, v201
  v_add_f32 v245, v202, v203
  v_mfma_f32_16x16x32_bf16 v[48:51], v[232:235], v[184:187], v[48:51]
  v_cndmask_b32 v244, v244, v245, s[4:5]
  v_rcp_f32 v244, v244
  v_mfma_f32_16x16x32_bf16 v[52:55], v[232:235], v[188:191], v[52:55]
  s_waitcnt lgkmcnt(14)
  v_mul_f32 v244, s100, v244
  v_cvt_pk_bf16_f32 v251, v244, v244
  v_mfma_f32_16x16x32_bf16 v[56:59], v[236:239], v[184:187], v[56:59]
  v_cvt_pk_bf16_f32 v0, v0, v1
  v_cvt_pk_bf16_f32 v1, v2, v3
  v_mfma_f32_16x16x32_bf16 v[60:63], v[236:239], v[188:191], v[60:63]
  s_waitcnt lgkmcnt(14)
  s_barrier
  v_cvt_pk_bf16_f32 v4, v4, v5
  v_cvt_pk_bf16_f32 v5, v6, v7
  v_mfma_f32_16x16x32_bf16 v[64:67], v[208:211], v[184:187], v[64:67]
  v_cvt_pk_bf16_f32 v8, v8, v9
  v_cvt_pk_bf16_f32 v9, v10, v11
  v_mfma_f32_16x16x32_bf16 v[68:71], v[208:211], v[188:191], v[68:71]
  s_waitcnt lgkmcnt(14)
  v_cvt_pk_bf16_f32 v12, v12, v13
  v_cvt_pk_bf16_f32 v13, v14, v15
  v_mfma_f32_16x16x32_bf16 v[72:75], v[212:215], v[184:187], v[72:75]
  v_cvt_pk_bf16_f32 v16, v16, v17
  v_cvt_pk_bf16_f32 v17, v18, v19
  v_mfma_f32_16x16x32_bf16 v[76:79], v[212:215], v[188:191], v[76:79]
  s_waitcnt lgkmcnt(10)
  v_cvt_pk_bf16_f32 v20, v20, v21
  v_cvt_pk_bf16_f32 v21, v22, v23
  v_mfma_f32_16x16x32_bf16 v[80:83], v[216:219], v[184:187], v[80:83]
  v_cvt_pk_bf16_f32 v24, v24, v25
  v_cvt_pk_bf16_f32 v25, v26, v27
  v_mfma_f32_16x16x32_bf16 v[84:87], v[216:219], v[188:191], v[84:87]
  s_waitcnt lgkmcnt(6)
  v_cvt_pk_bf16_f32 v28, v28, v29
  v_cvt_pk_bf16_f32 v29, v30, v31
  v_mfma_f32_16x16x32_bf16 v[88:91], v[220:223], v[184:187], v[88:91]
  v_cvt_pk_bf16_f32 v32, v32, v33
  v_cvt_pk_bf16_f32 v33, v34, v35
  v_mfma_f32_16x16x32_bf16 v[92:95], v[220:223], v[188:191], v[92:95]
  v_cvt_pk_bf16_f32 v36, v36, v37
  v_cvt_pk_bf16_f32 v37, v38, v39
  v_cvt_pk_bf16_f32 v40, v40, v41
  v_cvt_pk_bf16_f32 v41, v42, v43
  v_cvt_pk_bf16_f32 v44, v44, v45
  v_cvt_pk_bf16_f32 v45, v46, v47
  v_cvt_pk_bf16_f32 v48, v48, v49
  v_cvt_pk_bf16_f32 v49, v50, v51
  v_cvt_pk_bf16_f32 v52, v52, v53
  v_cvt_pk_bf16_f32 v53, v54, v55
  v_cvt_pk_bf16_f32 v56, v56, v57
  v_cvt_pk_bf16_f32 v57, v58, v59
  v_cvt_pk_bf16_f32 v60, v60, v61
  v_cvt_pk_bf16_f32 v61, v62, v63
  v_cvt_pk_bf16_f32 v64, v64, v65
  v_cvt_pk_bf16_f32 v65, v66, v67
  v_cvt_pk_bf16_f32 v68, v68, v69
  v_cvt_pk_bf16_f32 v69, v70, v71
  v_cvt_pk_bf16_f32 v72, v72, v73
  v_cvt_pk_bf16_f32 v73, v74, v75
  v_cvt_pk_bf16_f32 v76, v76, v77
  v_cvt_pk_bf16_f32 v77, v78, v79
  v_cvt_pk_bf16_f32 v80, v80, v81
  v_cvt_pk_bf16_f32 v81, v82, v83
  v_cvt_pk_bf16_f32 v84, v84, v85
  v_cvt_pk_bf16_f32 v85, v86, v87
  v_cvt_pk_bf16_f32 v88, v88, v89
  v_cvt_pk_bf16_f32 v89, v90, v91
  v_cvt_pk_bf16_f32 v92, v92, v93
  v_cvt_pk_bf16_f32 v93, v94, v95
  s_setprio 0
  v_add_u32 v252, 49664, v250
  v_subrev_u32 v253, 12416, v250
  v_min_u32 v250, v252, v253
  v_mbcnt_lo_u32_b32 v213, -1, 0
  v_mbcnt_hi_u32_b32 v213, -1, v213
  v_and_b32 v212, 1, v213
  v_lshlrev_b32 v212, 4, v212
  v_bfe_i32 v213, v213, 1, 1
  s_mov_b32 s60, 0x3dd5
  s_mov_b32 s61, 0x38ee
  v_lshlrev_b32 v209, v212, s60
  v_lshlrev_b32 v211, v212, s61
  v_bfi_b32 v208, v213, 0, v209
  v_bfi_b32 v210, v213, 0, v211
  v_and_b32 v209, v213, v209
  v_and_b32 v211, v213, v211
  s_add_u32 s60, s54, s3
  s_sub_u32 s55, 63, s60
  s_mov_b32 s56, 2
  s_waitcnt lgkmcnt(0)
  ds_write_b32 v254, v251 offset:51840
  ds_write_b64 v255, v[0:1] offset:51456
  ds_write_b64 v255, v[4:5] offset:53056
  ds_write_b64 v255, v[8:9] offset:51488
  ds_write_b64 v255, v[12:13] offset:53088
  ds_write_b64 v255, v[16:17] offset:51520
  ds_write_b64 v255, v[20:21] offset:53120
  ds_write_b64 v255, v[24:25] offset:51552
  ds_write_b64 v255, v[28:29] offset:53152
  ds_write_b64 v255, v[32:33] offset:51584
  ds_write_b64 v255, v[36:37] offset:53184
  ds_write_b64 v255, v[40:41] offset:51616
  ds_write_b64 v255, v[44:45] offset:53216
  ds_write_b64 v255, v[48:49] offset:51648
  ds_write_b64 v255, v[52:53] offset:53248
  ds_write_b64 v255, v[56:57] offset:51680
  s_barrier
  v_mfma_f32_4x4x4_16b_bf16 v[216:219], v[208:209], v[96:97], 0
  v_mfma_f32_4x4x4_16b_bf16 v[220:223], v[208:209], v[98:99], 0
  s_nop 0
  v_mfma_f32_4x4x4_16b_bf16 v[216:219], v[210:211], v[96:97], v[216:219]
  v_mfma_f32_4x4x4_16b_bf16 v[224:227], v[208:209], v[100:101], 0
  s_nop 0
  v_mfma_f32_4x4x4_16b_bf16 v[220:223], v[210:211], v[98:99], v[220:223]
  v_mfma_f32_4x4x4_16b_bf16 v[228:231], v[208:209], v[102:103], 0
  s_nop 0
  v_mfma_f32_4x4x4_16b_bf16 v[224:227], v[210:211], v[100:101], v[224:227]
  v_mfma_f32_4x4x4_16b_bf16 v[232:235], v[208:209], v[104:105], 0
  v_cvt_pk_bf16_f32 v96, v216, v217
  v_mfma_f32_4x4x4_16b_bf16 v[228:231], v[210:211], v[102:103], v[228:231]
  v_cvt_pk_bf16_f32 v97, v218, v219
  v_mfma_f32_4x4x4_16b_bf16 v[236:239], v[208:209], v[106:107], 0
  v_cvt_pk_bf16_f32 v98, v220, v221
  v_mfma_f32_4x4x4_16b_bf16 v[232:235], v[210:211], v[104:105], v[232:235]
  v_cvt_pk_bf16_f32 v99, v222, v223
  v_mfma_f32_4x4x4_16b_bf16 v[216:219], v[208:209], v[108:109], 0
  v_cvt_pk_bf16_f32 v100, v224, v225
  v_mfma_f32_4x4x4_16b_bf16 v[236:239], v[210:211], v[106:107], v[236:239]
  v_cvt_pk_bf16_f32 v101, v226, v227
  v_mfma_f32_4x4x4_16b_bf16 v[220:223], v[208:209], v[110:111], 0
  v_cvt_pk_bf16_f32 v102, v228, v229
  v_mfma_f32_4x4x4_16b_bf16 v[216:219], v[210:211], v[108:109], v[216:219]
  v_cvt_pk_bf16_f32 v103, v230, v231
  v_mfma_f32_4x4x4_16b_bf16 v[224:227], v[208:209], v[112:113], 0
  v_cvt_pk_bf16_f32 v104, v232, v233
  v_mfma_f32_4x4x4_16b_bf16 v[220:223], v[210:211], v[110:111], v[220:223]
  v_cvt_pk_bf16_f32 v105, v234, v235
  v_mfma_f32_4x4x4_16b_bf16 v[228:231], v[208:209], v[114:115], 0
  v_cvt_pk_bf16_f32 v106, v236, v237
  v_mfma_f32_4x4x4_16b_bf16 v[224:227], v[210:211], v[112:113], v[224:227]
  v_cvt_pk_bf16_f32 v107, v238, v239
  v_mfma_f32_4x4x4_16b_bf16 v[232:235], v[208:209], v[116:117], 0
  v_cvt_pk_bf16_f32 v108, v216, v217
  v_mfma_f32_4x4x4_16b_bf16 v[228:231], v[210:211], v[114:115], v[228:231]
  v_cvt_pk_bf16_f32 v109, v218, v219
  v_mfma_f32_4x4x4_16b_bf16 v[236:239], v[208:209], v[118:119], 0
  v_cvt_pk_bf16_f32 v110, v220, v221
  v_mfma_f32_4x4x4_16b_bf16 v[232:235], v[210:211], v[116:117], v[232:235]
  v_cvt_pk_bf16_f32 v111, v222, v223
  v_mfma_f32_4x4x4_16b_bf16 v[216:219], v[208:209], v[120:121], 0
  v_cvt_pk_bf16_f32 v112, v224, v225
  v_mfma_f32_4x4x4_16b_bf16 v[236:239], v[210:211], v[118:119], v[236:239]
  v_cvt_pk_bf16_f32 v113, v226, v227
  v_mfma_f32_4x4x4_16b_bf16 v[220:223], v[208:209], v[122:123], 0
  v_cvt_pk_bf16_f32 v114, v228, v229
  v_mfma_f32_4x4x4_16b_bf16 v[216:219], v[210:211], v[120:121], v[216:219]
  v_cvt_pk_bf16_f32 v115, v230, v231
  v_mfma_f32_4x4x4_16b_bf16 v[224:227], v[208:209], v[124:125], 0
  v_cvt_pk_bf16_f32 v116, v232, v233
  v_mfma_f32_4x4x4_16b_bf16 v[220:223], v[210:211], v[122:123], v[220:223]
  v_cvt_pk_bf16_f32 v117, v234, v235
  v_mfma_f32_4x4x4_16b_bf16 v[228:231], v[208:209], v[126:127], 0
  v_cvt_pk_bf16_f32 v118, v236, v237
  v_mfma_f32_4x4x4_16b_bf16 v[224:227], v[210:211], v[124:125], v[224:227]
  v_cvt_pk_bf16_f32 v119, v238, v239
  v_mfma_f32_4x4x4_16b_bf16 v[232:235], v[208:209], v[128:129], 0
  v_cvt_pk_bf16_f32 v120, v216, v217
  v_mfma_f32_4x4x4_16b_bf16 v[228:231], v[210:211], v[126:127], v[228:231]
  v_cvt_pk_bf16_f32 v121, v218, v219
  v_mfma_f32_4x4x4_16b_bf16 v[236:239], v[208:209], v[130:131], 0
  v_cvt_pk_bf16_f32 v122, v220, v221
  v_mfma_f32_4x4x4_16b_bf16 v[232:235], v[210:211], v[128:129], v[232:235]
  v_cvt_pk_bf16_f32 v123, v222, v223
  v_mfma_f32_4x4x4_16b_bf16 v[216:219], v[208:209], v[132:133], 0
  v_cvt_pk_bf16_f32 v124, v224, v225
  v_mfma_f32_4x4x4_16b_bf16 v[236:239], v[210:211], v[130:131], v[236:239]
  v_cvt_pk_bf16_f32 v125, v226, v227
  v_mfma_f32_4x4x4_16b_bf16 v[220:223], v[208:209], v[134:135], 0
  v_cvt_pk_bf16_f32 v126, v228, v229
  v_mfma_f32_4x4x4_16b_bf16 v[216:219], v[210:211], v[132:133], v[216:219]
  v_cvt_pk_bf16_f32 v127, v230, v231
  v_mfma_f32_4x4x4_16b_bf16 v[224:227], v[208:209], v[136:137], 0
  v_cvt_pk_bf16_f32 v128, v232, v233
  v_mfma_f32_4x4x4_16b_bf16 v[220:223], v[210:211], v[134:135], v[220:223]
  v_cvt_pk_bf16_f32 v129, v234, v235
  v_mfma_f32_4x4x4_16b_bf16 v[228:231], v[208:209], v[138:139], 0
  v_cvt_pk_bf16_f32 v130, v236, v237
  v_mfma_f32_4x4x4_16b_bf16 v[224:227], v[210:211], v[136:137], v[224:227]
  v_cvt_pk_bf16_f32 v131, v238, v239
  v_mfma_f32_4x4x4_16b_bf16 v[232:235], v[208:209], v[140:141], 0
  v_cvt_pk_bf16_f32 v132, v216, v217
  v_mfma_f32_4x4x4_16b_bf16 v[228:231], v[210:211], v[138:139], v[228:231]
  v_cvt_pk_bf16_f32 v133, v218, v219
  v_mfma_f32_4x4x4_16b_bf16 v[236:239], v[208:209], v[142:143], 0
  v_cvt_pk_bf16_f32 v134, v220, v221
  v_mfma_f32_4x4x4_16b_bf16 v[232:235], v[210:211], v[140:141], v[232:235]
  v_cvt_pk_bf16_f32 v135, v222, v223
  v_cvt_pk_bf16_f32 v136, v224, v225
  v_mfma_f32_4x4x4_16b_bf16 v[236:239], v[210:211], v[142:143], v[236:239]
  v_cvt_pk_bf16_f32 v137, v226, v227
  v_cvt_pk_bf16_f32 v138, v228, v229
  v_cvt_pk_bf16_f32 v139, v230, v231
  v_cvt_pk_bf16_f32 v140, v232, v233
  v_cvt_pk_bf16_f32 v141, v234, v235
  v_cvt_pk_bf16_f32 v142, v236, v237
  v_cvt_pk_bf16_f32 v143, v238, v239
  ds_write_b64 v255, v[60:61] offset:53280
  ds_write_b64 v255, v[64:65] offset:51712
  ds_write_b64 v255, v[68:69] offset:53312
  ds_write_b64 v255, v[72:73] offset:51744
  ds_write_b64 v255, v[76:77] offset:53344
  ds_write_b64 v255, v[80:81] offset:51776
  ds_write_b64 v255, v[84:85] offset:53376
  ds_write_b64 v255, v[88:89] offset:51808
  ds_write_b64 v255, v[92:93] offset:53408
  s_waitcnt lgkmcnt(0)
  s_barrier
  s_setprio 2
  ds_read_b128 v[208:211], v248 offset:0
  ds_read_b128 v[212:215], v248 offset:64
  ds_read_b128 v[216:219], v248 offset:128
  ds_read_b128 v[220:223], v248 offset:192
  ds_read_b128 v[224:227], v248 offset:256
  ds_read_b128 v[228:231], v248 offset:320
  ds_read_b128 v[232:235], v248 offset:1536
  ds_read_b128 v[236:239], v248 offset:1600
  v_mov_b64 v[0:1], 0
  v_mov_b64 v[2:3], 0
  v_mov_b64 v[4:5], 0
  v_mov_b64 v[6:7], 0
  v_mov_b64 v[8:9], 0
  v_mov_b64 v[10:11], 0
  v_mov_b64 v[12:13], 0
  v_mov_b64 v[14:15], 0
  v_mov_b64 v[16:17], 0
  v_mov_b64 v[18:19], 0
  v_mov_b64 v[20:21], 0
  v_mov_b64 v[22:23], 0
  s_waitcnt lgkmcnt(7)
  v_mfma_f32_16x16x32_bf16 v[160:163], v[208:211], v[96:99], 0
  v_mov_b64 v[24:25], 0
  v_mov_b64 v[26:27], 0
  v_mfma_f32_16x16x32_bf16 v[164:167], v[208:211], v[120:123], 0
  ds_read_b128 v[208:211], v248 offset:1664
  v_mov_b64 v[28:29], 0
  s_waitcnt lgkmcnt(6)
  v_mfma_f32_16x16x32_bf16 v[160:163], v[212:215], v[100:103], v[160:163]
  v_mov_b64 v[30:31], 0
  v_mov_b64 v[32:33], 0
  v_mfma_f32_16x16x32_bf16 v[164:167], v[212:215], v[124:127], v[164:167]
  ds_read_b128 v[212:215], v248 offset:1728
  v_mov_b64 v[34:35], 0
  v_mfma_f32_16x16x32_bf16 v[160:163], v[216:219], v[104:107], v[160:163]
  v_mov_b64 v[36:37], 0
  v_mov_b64 v[38:39], 0
  v_mfma_f32_16x16x32_bf16 v[164:167], v[216:219], v[128:131], v[164:167]
  ds_read_b128 v[216:219], v248 offset:1792
  v_mov_b64 v[40:41], 0
  s_waitcnt lgkmcnt(5)
  v_mfma_f32_16x16x32_bf16 v[160:163], v[220:223], v[108:111], v[160:163]
  v_mov_b64 v[42:43], 0
  v_mov_b64 v[44:45], 0
  v_mfma_f32_16x16x32_bf16 v[164:167], v[220:223], v[132:135], v[164:167]
  ds_read_b128 v[220:223], v248 offset:1856
  v_mov_b64 v[46:47], 0
  v_mfma_f32_16x16x32_bf16 v[160:163], v[224:227], v[112:115], v[160:163]
  v_mov_b64 v[48:49], 0
  v_mov_b64 v[50:51], 0
  v_mfma_f32_16x16x32_bf16 v[164:167], v[224:227], v[136:139], v[164:167]
  v_mov_b64 v[52:53], 0
  v_mov_b64 v[54:55], 0
  v_mfma_f32_16x16x32_bf16 v[160:163], v[228:231], v[116:119], v[160:163]
  v_mov_b64 v[56:57], 0
  v_mov_b64 v[58:59], 0
  v_mfma_f32_16x16x32_bf16 v[164:167], v[228:231], v[140:143], v[164:167]
  v_mov_b64 v[60:61], 0
  v_mov_b64 v[62:63], 0
  s_waitcnt lgkmcnt(3)
  v_mfma_f32_16x16x32_bf16 v[168:171], v[232:235], v[96:99], 0
  v_mov_b64 v[64:65], 0
  v_mov_b64 v[66:67], 0
  v_mfma_f32_16x16x32_bf16 v[172:175], v[232:235], v[120:123], 0
  v_mov_b64 v[68:69], 0
  v_mov_b64 v[70:71], 0
  v_mfma_f32_16x16x32_bf16 v[168:171], v[236:239], v[100:103], v[168:171]
  v_mov_b64 v[72:73], 0
  v_mov_b64 v[74:75], 0
  v_mfma_f32_16x16x32_bf16 v[172:175], v[236:239], v[124:127], v[172:175]
  v_mov_b64 v[76:77], 0
  v_mov_b64 v[78:79], 0
  v_mfma_f32_16x16x32_bf16 v[168:171], v[208:211], v[104:107], v[168:171]
  v_mov_b64 v[80:81], 0
  v_mov_b64 v[82:83], 0
  v_mfma_f32_16x16x32_bf16 v[172:175], v[208:211], v[128:131], v[172:175]
  v_mov_b64 v[84:85], 0
  v_mov_b64 v[86:87], 0
  s_waitcnt lgkmcnt(0)
  v_mfma_f32_16x16x32_bf16 v[168:171], v[212:215], v[108:111], v[168:171]
  v_mov_b64 v[88:89], 0
  v_mov_b64 v[90:91], 0
  v_mfma_f32_16x16x32_bf16 v[172:175], v[212:215], v[132:135], v[172:175]
  v_mov_b64 v[92:93], 0
  v_mov_b64 v[94:95], 0
  v_mfma_f32_16x16x32_bf16 v[168:171], v[216:219], v[112:115], v[168:171]
  v_mov_b64 v[200:201], 0
  v_mov_b64 v[202:203], 0
  v_mfma_f32_16x16x32_bf16 v[172:175], v[216:219], v[136:139], v[172:175]
  v_mfma_f32_16x16x32_bf16 v[168:171], v[220:223], v[116:119], v[168:171]
  v_mfma_f32_16x16x32_bf16 v[172:175], v[220:223], v[140:143], v[172:175]
  s_nop 5
  s_cmp_eq_u32 s56, 0
  s_cbranch_scc1 L_nomask0
  v_mov_b32 v251, 0xff800000
  v_cndmask_b32 v160, v160, v251, s[64:65]
  v_cndmask_b32 v161, v161, v251, s[66:67]
  v_cndmask_b32 v162, v162, v251, s[68:69]
  v_cndmask_b32 v163, v163, v251, s[70:71]
  v_cndmask_b32 v164, v164, v251, s[72:73]
  v_cndmask_b32 v165, v165, v251, s[74:75]
  v_cndmask_b32 v166, v166, v251, s[76:77]
  v_cndmask_b32 v167, v167, v251, s[78:79]
  v_cndmask_b32 v168, v168, v251, s[80:81]
  v_cndmask_b32 v169, v169, v251, s[82:83]
  v_cndmask_b32 v170, v170, v251, s[84:85]
  v_cndmask_b32 v171, v171, v251, s[86:87]
  v_cndmask_b32 v172, v172, v251, s[88:89]
  v_cndmask_b32 v173, v173, v251, s[90:91]
  v_cndmask_b32 v174, v174, v251, s[92:93]
  v_cndmask_b32 v175, v175, v251, s[94:95]
L_nomask0:
  v_max3_f32 v252, v160, v161, v162
  v_max3_f32 v252, v252, v163, v168
  v_max3_f32 v252, v252, v169, v170
  v_max_f32 v252, v252, v171
  v_max3_f32 v246, v164, v165, v166
  v_max3_f32 v246, v246, v167, v172
  v_max3_f32 v246, v246, v173, v174
  v_max_f32 v246, v246, v175
  s_nop 1
  v_permlane32_swap_b32 v252, v246
  v_max_f32 v252, v252, v246
  v_mov_b32 v246, v252
  s_nop 1
  v_permlane16_swap_b32 v252, v246
  v_max_f32 v252, v252, v246
  v_mov_b32 v246, v252
  s_nop 1
  v_permlane32_swap_b32 v252, v246
  v_sub_f32 v252, 0xc1800000, v252
  v_sub_f32 v246, 0xc1800000, v246
  v_mov_b32 v253, v252
  v_mov_b32 v247, v246
  s_sub_u32 s55, s55, 1
  v_pk_add_f32 v[160:161], v[160:161], v[252:253]
  v_pk_add_f32 v[162:163], v[162:163], v[252:253]
  v_pk_add_f32 v[164:165], v[164:165], v[246:247]
  v_pk_add_f32 v[166:167], v[166:167], v[246:247]
  v_pk_add_f32 v[168:169], v[168:169], v[252:253]
  v_pk_add_f32 v[170:171], v[170:171], v[252:253]
  v_pk_add_f32 v[172:173], v[172:173], v[246:247]
  v_pk_add_f32 v[174:175], v[174:175], v[246:247]
  v_mov_b64 v[192:193], v[252:253]
  v_mov_b64 v[194:195], v[252:253]
  v_mov_b64 v[196:197], v[246:247]
  v_mov_b64 v[198:199], v[246:247]
  s_barrier
  ds_read_b128 v[208:211], v248 offset:12416
  ds_read_b128 v[212:215], v248 offset:12480
  ds_read_b128 v[216:219], v248 offset:12544
  ds_read_b128 v[220:223], v248 offset:12608
  ds_read_b128 v[224:227], v248 offset:12672
  ds_read_b128 v[228:231], v248 offset:12736
  ds_read_b128 v[232:235], v248 offset:13952
  v_exp_f32 v244, v160
  v_exp_f32 v245, v161
  v_exp_f32 v246, v162
  v_exp_f32 v247, v163
  v_exp_f32 v205, v164
  v_cvt_pk_bf16_f32 v184, v244, v245
  v_cvt_pk_bf16_f32 v185, v246, v247
  v_exp_f32 v206, v165
  s_nop 0
  v_cvt_pk_bf16_f32 v188, v205, v206
  v_or3_b32 v251, v184, v185, v188
  v_exp_f32 v244, v166
  s_waitcnt lgkmcnt(6)
  s_cbranch_scc1 L_ev1
  s_bitcmp1_b32 s3, 1
  s_cbranch_scc1 L_step1b
  s_branch L_step1
L_ev1:
  s_cmp_eq_u32 s56, 0
  s_cbranch_scc0 L_end
  v_mfma_f32_16x16x32_bf16 v[144:147], v[208:211], v[96:99], v[192:195]
  s_waitcnt lgkmcnt(5)
  ds_read_b128 v[236:239], v248 offset:14016
  v_mfma_f32_16x16x32_bf16 v[144:147], v[212:215], v[100:103], v[144:147]
  s_waitcnt lgkmcnt(5)
  v_exp_f32 v245, v167
  v_mfma_f32_16x16x32_bf16 v[144:147], v[216:219], v[104:107], v[144:147]
  s_waitcnt lgkmcnt(4)
  v_exp_f32 v246, v168
  v_mfma_f32_16x16x32_bf16 v[144:147], v[220:223], v[108:111], v[144:147]
  s_waitcnt lgkmcnt(3)
  v_exp_f32 v247, v169
  v_mfma_f32_16x16x32_bf16 v[144:147], v[224:227], v[112:115], v[144:147]
  s_waitcnt lgkmcnt(2)
  v_exp_f32 v205, v170
  v_mfma_f32_16x16x32_bf16 v[144:147], v[228:231], v[116:119], v[144:147]
  v_exp_f32 v206, v171
  v_mfma_f32_16x16x32_bf16 v[148:151], v[208:211], v[120:123], v[196:199]
  ds_read_b128 v[208:211], v248 offset:14080
  v_cvt_pk_bf16_f32 v189, v244, v245
  v_mfma_f32_16x16x32_bf16 v[148:151], v[212:215], v[124:127], v[148:151]
  ds_read_b128 v[212:215], v248 offset:14144
  v_cvt_pk_bf16_f32 v186, v246, v247
  v_mfma_f32_16x16x32_bf16 v[148:151], v[216:219], v[128:131], v[148:151]
  ds_read_b128 v[216:219], v248 offset:14208
  v_cvt_pk_bf16_f32 v187, v205, v206
  v_mfma_f32_16x16x32_bf16 v[148:151], v[220:223], v[132:135], v[148:151]
  ds_read_b128 v[220:223], v248 offset:14272
  v_or3_b32 v251, v251, v189, v186
  v_mfma_f32_16x16x32_bf16 v[148:151], v[224:227], v[136:139], v[148:151]
  ds_read_b64_tr_b16 v[224:225], v250 offset:0
  v_mfma_f32_16x16x32_bf16 v[148:151], v[228:231], v[140:143], v[148:151]
  s_waitcnt lgkmcnt(6)
  ds_read_b64_tr_b16 v[226:227], v250 offset:1536
  v_swap_b32 v248, v249
  v_mfma_f32_16x16x32_bf16 v[152:155], v[232:235], v[96:99], v[192:195]
  s_waitcnt lgkmcnt(6)
  v_exp_f32 v244, v172
  v_mfma_f32_16x16x32_bf16 v[152:155], v[236:239], v[100:103], v[152:155]
  s_waitcnt lgkmcnt(5)
  v_exp_f32 v245, v173
  v_mfma_f32_16x16x32_bf16 v[152:155], v[208:211], v[104:107], v[152:155]
  s_waitcnt lgkmcnt(4)
  v_exp_f32 v246, v174
  v_mfma_f32_16x16x32_bf16 v[152:155], v[212:215], v[108:111], v[152:155]
  s_waitcnt lgkmcnt(3)
  v_exp_f32 v247, v175
  v_mfma_f32_16x16x32_bf16 v[152:155], v[216:219], v[112:115], v[152:155]
  s_waitcnt lgkmcnt(2)
  ds_read_b64_tr_b16 v[228:229], v250 offset:32
  v_cvt_pk_bf16_f32 v190, v244, v245
  v_mfma_f32_16x16x32_bf16 v[152:155], v[220:223], v[116:119], v[152:155]
  ds_read_b64_tr_b16 v[230:231], v250 offset:1568
  v_cvt_pk_bf16_f32 v191, v246, v247
  v_mfma_f32_16x16x32_bf16 v[156:159], v[232:235], v[120:123], v[196:199]
  ds_read_b64_tr_b16 v[232:233], v250 offset:64
  v_or3_b32 v251, v251, v187, v190
  v_mfma_f32_16x16x32_bf16 v[156:159], v[236:239], v[124:127], v[156:159]
  ds_read_b64_tr_b16 v[234:235], v250 offset:1600
  v_bitop3_b32 v251, v251, v191, s57 bitop3:0xa8
  v_mfma_f32_16x16x32_bf16 v[156:159], v[208:211], v[128:131], v[156:159]
  ds_read_b64_tr_b16 v[236:237], v250 offset:96
  v_cmp_ne_u32 vcc, 0, v251
  v_mfma_f32_16x16x32_bf16 v[156:159], v[212:215], v[132:135], v[156:159]
  ds_read_b64_tr_b16 v[238:239], v250 offset:1632
  v_mfma_f32_16x16x32_bf16 v[156:159], v[216:219], v[136:139], v[156:159]
  s_cbranch_vccnz L_stub6
L_chkret6:
  v_mfma_f32_16x16x32_bf16 v[156:159], v[220:223], v[140:143], v[156:159]
  s_waitcnt lgkmcnt(6)
  ds_read_b64_tr_b16 v[208:209], v250 offset:128
  ds_read_b64_tr_b16 v[210:211], v250 offset:1664
  v_mfma_f32_16x16x32_bf16 v[0:3], v[224:227], v[184:187], v[0:3]
  v_mfma_f32_16x16x32_bf16 v[4:7], v[224:227], v[188:191], v[4:7]
  s_waitcnt lgkmcnt(6)
  ds_read_b64_tr_b16 v[212:213], v250 offset:160
  ds_read_b64_tr_b16 v[214:215], v250 offset:1696
  v_mfma_f32_16x16x32_bf16 v[8:11], v[228:231], v[184:187], v[8:11]
  v_mfma_f32_16x16x32_bf16 v[12:15], v[228:231], v[188:191], v[12:15]
  s_waitcnt lgkmcnt(6)
  ds_read_b64_tr_b16 v[216:217], v250 offset:192
  ds_read_b64_tr_b16 v[218:219], v250 offset:1728
  v_mfma_f32_16x16x32_bf16 v[16:19], v[232:235], v[184:187], v[16:19]
  v_mfma_f32_16x16x32_bf16 v[20:23], v[232:235], v[188:191], v[20:23]
  s_waitcnt lgkmcnt(6)
  ds_read_b64_tr_b16 v[220:221], v250 offset:224
  ds_read_b64_tr_b16 v[222:223], v250 offset:1760
  v_mfma_f32_16x16x32_bf16 v[24:27], v[236:239], v[184:187], v[24:27]
  v_mfma_f32_16x16x32_bf16 v[28:31], v[236:239], v[188:191], v[28:31]
  s_waitcnt lgkmcnt(6)
  ds_read_b64_tr_b16 v[224:225], v250 offset:256
  ds_read_b64_tr_b16 v[226:227], v250 offset:1792
  v_mfma_f32_16x16x32_bf16 v[32:35], v[208:211], v[184:187], v[32:35]
  v_mfma_f32_16x16x32_bf16 v[36:39], v[208:211], v[188:191], v[36:39]
  s_waitcnt lgkmcnt(6)
  ds_read_b64_tr_b16 v[228:229], v250 offset:288
  v_mfma_f32_16x16x32_bf16 v[40:43], v[212:215], v[184:187], v[40:43]
  ds_read_b64_tr_b16 v[230:231], v250 offset:1824
  v_mfma_f32_16x16x32_bf16 v[44:47], v[212:215], v[188:191], v[44:47]
  s_waitcnt lgkmcnt(6)
  ds_read_b64_tr_b16 v[232:233], v250 offset:320
  v_add_u32 v252, 12416, v250
  v_mfma_f32_16x16x32_bf16 v[48:51], v[216:219], v[184:187], v[48:51]
  ds_read_b64_tr_b16 v[234:235], v250 offset:1856
  v_add_u32 v253, 0xffff3e00, v250
  v_mfma_f32_16x16x32_bf16 v[52:55], v[216:219], v[188:191], v[52:55]
  s_waitcnt lgkmcnt(6)
  v_mfma_f32_16x16x32_bf16 v[56:59], v[220:223], v[184:187], v[56:59]
  ds_read_b64_tr_b16 v[236:237], v250 offset:352
  ds_read_b64_tr_b16 v[238:239], v250 offset:1888
  v_smfmac_f32_16x16x64_bf16 v[200:203], v[240:243], v[184:191], v204
  s_barrier
  v_mfma_f32_16x16x32_bf16 v[60:63], v[220:223], v[188:191], v[60:63]
  s_waitcnt lgkmcnt(6)
  ds_read_b128 v[208:211], v248 offset:0
  v_min_u32 v250, v252, v253
  v_mfma_f32_16x16x32_bf16 v[64:67], v[224:227], v[184:187], v[64:67]
  ds_read_b128 v[212:215], v248 offset:64
  v_mfma_f32_16x16x32_bf16 v[68:71], v[224:227], v[188:191], v[68:71]
  s_waitcnt lgkmcnt(6)
  ds_read_b128 v[216:219], v248 offset:128
  v_mfma_f32_16x16x32_bf16 v[72:75], v[228:231], v[184:187], v[72:75]
  ds_read_b128 v[220:223], v248 offset:192
  v_mfma_f32_16x16x32_bf16 v[76:79], v[228:231], v[188:191], v[76:79]
  s_waitcnt lgkmcnt(6)
  ds_read_b128 v[224:227], v248 offset:256
  v_mfma_f32_16x16x32_bf16 v[80:83], v[232:235], v[184:187], v[80:83]
  ds_read_b128 v[228:231], v248 offset:320
  v_mfma_f32_16x16x32_bf16 v[84:87], v[232:235], v[188:191], v[84:87]
  s_waitcnt lgkmcnt(6)
  ds_read_b128 v[232:235], v248 offset:1536
  v_mfma_f32_16x16x32_bf16 v[88:91], v[236:239], v[184:187], v[88:91]
  s_waitcnt lgkmcnt(6)
  v_mfma_f32_16x16x32_bf16 v[92:95], v[236:239], v[188:191], v[92:95]
  ds_read_b64_tr_b16 v[208:209], v250 offset:0
  ds_read_b64_tr_b16 v[210:211], v250 offset:1536
  ds_read_b64_tr_b16 v[212:213], v250 offset:32
  ds_read_b64_tr_b16 v[214:215], v250 offset:1568
  ds_read_b64_tr_b16 v[216:217], v250 offset:64
  ds_read_b64_tr_b16 v[218:219], v250 offset:1600
  ds_read_b64_tr_b16 v[220:221], v250 offset:96
  ds_read_b64_tr_b16 v[222:223], v250 offset:1632
  ds_read_b64_tr_b16 v[224:225], v250 offset:128
  ds_read_b64_tr_b16 v[226:227], v250 offset:1664
  ds_read_b64_tr_b16 v[228:229], v250 offset:160
  ds_read_b64_tr_b16 v[230:231], v250 offset:1696
  ds_read_b64_tr_b16 v[232:233], v250 offset:192
  ds_read_b64_tr_b16 v[234:235], v250 offset:1728
  ds_read_b64_tr_b16 v[236:237], v250 offset:224
  ds_read_b64_tr_b16 v[238:239], v250 offset:1760
  v_mov_b32 v251, 0xff800000
  v_cndmask_b32 v144, v144, v251, s[64:65]
  v_cndmask_b32 v145, v145, v251, s[66:67]
  v_cndmask_b32 v146, v146, v251, s[68:69]
  v_cndmask_b32 v147, v147, v251, s[70:71]
  v_cndmask_b32 v148, v148, v251, s[72:73]
  v_cndmask_b32 v149, v149, v251, s[74:75]
  v_cndmask_b32 v150, v150, v251, s[76:77]
  v_cndmask_b32 v151, v151, v251, s[78:79]
  v_cndmask_b32 v152, v152, v251, s[80:81]
  v_cndmask_b32 v153, v153, v251, s[82:83]
  v_cndmask_b32 v154, v154, v251, s[84:85]
  v_cndmask_b32 v155, v155, v251, s[86:87]
  v_cndmask_b32 v156, v156, v251, s[88:89]
  v_cndmask_b32 v157, v157, v251, s[90:91]
  v_cndmask_b32 v158, v158, v251, s[92:93]
  v_cndmask_b32 v159, v159, v251, s[94:95]
  v_exp_f32 v244, v144
  v_exp_f32 v245, v145
  v_exp_f32 v246, v146
  v_exp_f32 v247, v147
  v_exp_f32 v205, v148
  v_cvt_pk_bf16_f32 v176, v244, v245
  v_cvt_pk_bf16_f32 v177, v246, v247
  v_exp_f32 v206, v149
  s_nop 0
  v_cvt_pk_bf16_f32 v180, v205, v206
  v_or3_b32 v251, v176, v177, v180
  v_exp_f32 v244, v150
  v_exp_f32 v245, v151
  v_exp_f32 v246, v152
  v_exp_f32 v247, v153
  v_exp_f32 v205, v154
  v_exp_f32 v206, v155
  v_cvt_pk_bf16_f32 v181, v244, v245
  v_cvt_pk_bf16_f32 v178, v246, v247
  v_cvt_pk_bf16_f32 v179, v205, v206
  v_or3_b32 v251, v251, v181, v178
  v_exp_f32 v244, v156
  v_exp_f32 v245, v157
  v_exp_f32 v246, v158
  v_exp_f32 v247, v159
  v_cvt_pk_bf16_f32 v182, v244, v245
  v_cvt_pk_bf16_f32 v183, v246, v247
  v_or3_b32 v251, v251, v179, v182
  v_bitop3_b32 v251, v251, v183, s57 bitop3:0xa8
  v_cmp_ne_u32 vcc, 0, v251
  s_waitcnt lgkmcnt(14)
  s_cbranch_vccnz L_stub7
L_chkret7:
  v_smfmac_f32_16x16x64_bf16 v[200:203], v[240:243], v[176:183], v204
  v_mfma_f32_16x16x32_bf16 v[0:3], v[208:211], v[176:179], v[0:3]
  v_min_u32 v252, v248, v249
  v_add_u32 v252, s99, v252
  v_mfma_f32_16x16x32_bf16 v[4:7], v[208:211], v[180:183], v[4:7]
  s_waitcnt lgkmcnt(12)
  ds_read_b64_tr_b16 v[208:209], v250 offset:256
  ds_read_b64_tr_b16 v[210:211], v250 offset:1792
  v_mfma_f32_16x16x32_bf16 v[8:11], v[212:215], v[176:179], v[8:11]
  ds_read_b128 v[96:99], v252 offset:50304
  ds_read_b128 v[100:103], v252 offset:50368
  v_mfma_f32_16x16x32_bf16 v[12:15], v[212:215], v[180:183], v[12:15]
  s_waitcnt lgkmcnt(14)
  ds_read_b64_tr_b16 v[212:213], v250 offset:288
  ds_read_b64_tr_b16 v[214:215], v250 offset:1824
  v_mfma_f32_16x16x32_bf16 v[16:19], v[216:219], v[176:179], v[16:19]
  ds_read_b128 v[104:107], v252 offset:50432
  ds_read_b128 v[108:111], v252 offset:50496
  v_mfma_f32_16x16x32_bf16 v[20:23], v[216:219], v[180:183], v[20:23]
  s_waitcnt lgkmcnt(14)
  ds_read_b64_tr_b16 v[216:217], v250 offset:320
  ds_read_b64_tr_b16 v[218:219], v250 offset:1856
  v_mfma_f32_16x16x32_bf16 v[24:27], v[220:223], v[176:179], v[24:27]
  ds_read_b128 v[112:115], v252 offset:50560
  ds_read_b128 v[116:119], v252 offset:50624
  v_mfma_f32_16x16x32_bf16 v[28:31], v[220:223], v[180:183], v[28:31]
  s_waitcnt lgkmcnt(14)
  ds_read_b64_tr_b16 v[220:221], v250 offset:352
  ds_read_b64_tr_b16 v[222:223], v250 offset:1888
  v_mfma_f32_16x16x32_bf16 v[32:35], v[224:227], v[176:179], v[32:35]
  ds_read_b128 v[120:123], v252 offset:51840
  ds_read_b128 v[124:127], v252 offset:51904
  v_mfma_f32_16x16x32_bf16 v[36:39], v[224:227], v[180:183], v[36:39]
  s_waitcnt lgkmcnt(14)
  ds_read_b128 v[128:131], v252 offset:51968
  ds_read_b128 v[132:135], v252 offset:52032
  v_mfma_f32_16x16x32_bf16 v[40:43], v[228:231], v[176:179], v[40:43]
  ds_read_b128 v[136:139], v252 offset:52096
  ds_read_b128 v[140:143], v252 offset:52160
  v_mfma_f32_16x16x32_bf16 v[44:47], v[228:231], v[180:183], v[44:47]
  s_waitcnt lgkmcnt(14)
  v_add_f32 v244, v200, v201
  v_add_f32 v245, v202, v203
  v_mfma_f32_16x16x32_bf16 v[48:51], v[232:235], v[176:179], v[48:51]
  v_cndmask_b32 v244, v244, v245, s[4:5]
  v_rcp_f32 v244, v244
  v_mfma_f32_16x16x32_bf16 v[52:55], v[232:235], v[180:183], v[52:55]
  s_waitcnt lgkmcnt(14)
  v_mul_f32 v244, s100, v244
  v_cvt_pk_bf16_f32 v251, v244, v244
  v_mfma_f32_16x16x32_bf16 v[56:59], v[236:239], v[176:179], v[56:59]
  v_cvt_pk_bf16_f32 v0, v0, v1
  v_cvt_pk_bf16_f32 v1, v2, v3
  v_mfma_f32_16x16x32_bf16 v[60:63], v[236:239], v[180:183], v[60:63]
  s_waitcnt lgkmcnt(14)
  s_barrier
  v_cvt_pk_bf16_f32 v4, v4, v5
  v_cvt_pk_bf16_f32 v5, v6, v7
  v_mfma_f32_16x16x32_bf16 v[64:67], v[208:211], v[176:179], v[64:67]
  v_cvt_pk_bf16_f32 v8, v8, v9
  v_cvt_pk_bf16_f32 v9, v10, v11
  v_mfma_f32_16x16x32_bf16 v[68:71], v[208:211], v[180:183], v[68:71]
  s_waitcnt lgkmcnt(14)
  v_cvt_pk_bf16_f32 v12, v12, v13
  v_cvt_pk_bf16_f32 v13, v14, v15
  v_mfma_f32_16x16x32_bf16 v[72:75], v[212:215], v[176:179], v[72:75]
  v_cvt_pk_bf16_f32 v16, v16, v17
  v_cvt_pk_bf16_f32 v17, v18, v19
  v_mfma_f32_16x16x32_bf16 v[76:79], v[212:215], v[180:183], v[76:79]
  s_waitcnt lgkmcnt(10)
  v_cvt_pk_bf16_f32 v20, v20, v21
  v_cvt_pk_bf16_f32 v21, v22, v23
  v_mfma_f32_16x16x32_bf16 v[80:83], v[216:219], v[176:179], v[80:83]
  v_cvt_pk_bf16_f32 v24, v24, v25
  v_cvt_pk_bf16_f32 v25, v26, v27
  v_mfma_f32_16x16x32_bf16 v[84:87], v[216:219], v[180:183], v[84:87]
  s_waitcnt lgkmcnt(6)
  v_cvt_pk_bf16_f32 v28, v28, v29
  v_cvt_pk_bf16_f32 v29, v30, v31
  v_mfma_f32_16x16x32_bf16 v[88:91], v[220:223], v[176:179], v[88:91]
  v_cvt_pk_bf16_f32 v32, v32, v33
  v_cvt_pk_bf16_f32 v33, v34, v35
  v_mfma_f32_16x16x32_bf16 v[92:95], v[220:223], v[180:183], v[92:95]
  v_cvt_pk_bf16_f32 v36, v36, v37
  v_cvt_pk_bf16_f32 v37, v38, v39
  v_cvt_pk_bf16_f32 v40, v40, v41
  v_cvt_pk_bf16_f32 v41, v42, v43
  v_cvt_pk_bf16_f32 v44, v44, v45
  v_cvt_pk_bf16_f32 v45, v46, v47
  v_cvt_pk_bf16_f32 v48, v48, v49
  v_cvt_pk_bf16_f32 v49, v50, v51
  v_cvt_pk_bf16_f32 v52, v52, v53
  v_cvt_pk_bf16_f32 v53, v54, v55
  v_cvt_pk_bf16_f32 v56, v56, v57
  v_cvt_pk_bf16_f32 v57, v58, v59
  v_cvt_pk_bf16_f32 v60, v60, v61
  v_cvt_pk_bf16_f32 v61, v62, v63
  v_cvt_pk_bf16_f32 v64, v64, v65
  v_cvt_pk_bf16_f32 v65, v66, v67
  v_cvt_pk_bf16_f32 v68, v68, v69
  v_cvt_pk_bf16_f32 v69, v70, v71
  v_cvt_pk_bf16_f32 v72, v72, v73
  v_cvt_pk_bf16_f32 v73, v74, v75
  v_cvt_pk_bf16_f32 v76, v76, v77
  v_cvt_pk_bf16_f32 v77, v78, v79
  v_cvt_pk_bf16_f32 v80, v80, v81
  v_cvt_pk_bf16_f32 v81, v82, v83
  v_cvt_pk_bf16_f32 v84, v84, v85
  v_cvt_pk_bf16_f32 v85, v86, v87
  v_cvt_pk_bf16_f32 v88, v88, v89
  v_cvt_pk_bf16_f32 v89, v90, v91
  v_cvt_pk_bf16_f32 v92, v92, v93
  v_cvt_pk_bf16_f32 v93, v94, v95
  s_setprio 0
  v_add_u32 v252, 49664, v250
  v_subrev_u32 v253, 12416, v250
  v_min_u32 v250, v252, v253
  v_swap_b32 v248, v249
  v_mbcnt_lo_u32_b32 v213, -1, 0
  v_mbcnt_hi_u32_b32 v213, -1, v213
  v_and_b32 v212, 1, v213
  v_lshlrev_b32 v212, 4, v212
  v_bfe_i32 v213, v213, 1, 1
  s_mov_b32 s60, 0x3dd5
  s_mov_b32 s61, 0x38ee
  v_lshlrev_b32 v209, v212, s60
  v_lshlrev_b32 v211, v212, s61
  v_bfi_b32 v208, v213, 0, v209
  v_bfi_b32 v210, v213, 0, v211
  v_and_b32 v209, v213, v209
  v_and_b32 v211, v213, v211
  s_add_u32 s60, s54, s3
  s_sub_u32 s55, 63, s60
  s_waitcnt lgkmcnt(0)
  ds_write_b32 v254, v251 offset:51840
  ds_write_b64 v255, v[0:1] offset:51456
  ds_write_b64 v255, v[4:5] offset:53056
  ds_write_b64 v255, v[8:9] offset:51488
  ds_write_b64 v255, v[12:13] offset:53088
  ds_write_b64 v255, v[16:17] offset:51520
  ds_write_b64 v255, v[20:21] offset:53120
  ds_write_b64 v255, v[24:25] offset:51552
  ds_write_b64 v255, v[28:29] offset:53152
  ds_write_b64 v255, v[32:33] offset:51584
  ds_write_b64 v255, v[36:37] offset:53184
  ds_write_b64 v255, v[40:41] offset:51616
  ds_write_b64 v255, v[44:45] offset:53216
  ds_write_b64 v255, v[48:49] offset:51648
  ds_write_b64 v255, v[52:53] offset:53248
  ds_write_b64 v255, v[56:57] offset:51680
  s_barrier
  s_mov_b32 s56, 2
  v_mfma_f32_4x4x4_16b_bf16 v[216:219], v[208:209], v[96:97], 0
  v_mfma_f32_4x4x4_16b_bf16 v[220:223], v[208:209], v[98:99], 0
  s_nop 0
  v_mfma_f32_4x4x4_16b_bf16 v[216:219], v[210:211], v[96:97], v[216:219]
  v_mfma_f32_4x4x4_16b_bf16 v[224:227], v[208:209], v[100:101], 0
  s_nop 0
  v_mfma_f32_4x4x4_16b_bf16 v[220:223], v[210:211], v[98:99], v[220:223]
  v_mfma_f32_4x4x4_16b_bf16 v[228:231], v[208:209], v[102:103], 0
  s_nop 0
  v_mfma_f32_4x4x4_16b_bf16 v[224:227], v[210:211], v[100:101], v[224:227]
  v_mfma_f32_4x4x4_16b_bf16 v[232:235], v[208:209], v[104:105], 0
  v_cvt_pk_bf16_f32 v96, v216, v217
  v_mfma_f32_4x4x4_16b_bf16 v[228:231], v[210:211], v[102:103], v[228:231]
  v_cvt_pk_bf16_f32 v97, v218, v219
  v_mfma_f32_4x4x4_16b_bf16 v[236:239], v[208:209], v[106:107], 0
  v_cvt_pk_bf16_f32 v98, v220, v221
  v_mfma_f32_4x4x4_16b_bf16 v[232:235], v[210:211], v[104:105], v[232:235]
  v_cvt_pk_bf16_f32 v99, v222, v223
  v_mfma_f32_4x4x4_16b_bf16 v[216:219], v[208:209], v[108:109], 0
  v_cvt_pk_bf16_f32 v100, v224, v225
  v_mfma_f32_4x4x4_16b_bf16 v[236:239], v[210:211], v[106:107], v[236:239]
  v_cvt_pk_bf16_f32 v101, v226, v227
  v_mfma_f32_4x4x4_16b_bf16 v[220:223], v[208:209], v[110:111], 0
  v_cvt_pk_bf16_f32 v102, v228, v229
  v_mfma_f32_4x4x4_16b_bf16 v[216:219], v[210:211], v[108:109], v[216:219]
  v_cvt_pk_bf16_f32 v103, v230, v231
  v_mfma_f32_4x4x4_16b_bf16 v[224:227], v[208:209], v[112:113], 0
  v_cvt_pk_bf16_f32 v104, v232, v233
  v_mfma_f32_4x4x4_16b_bf16 v[220:223], v[210:211], v[110:111], v[220:223]
  v_cvt_pk_bf16_f32 v105, v234, v235
  v_mfma_f32_4x4x4_16b_bf16 v[228:231], v[208:209], v[114:115], 0
  v_cvt_pk_bf16_f32 v106, v236, v237
  v_mfma_f32_4x4x4_16b_bf16 v[224:227], v[210:211], v[112:113], v[224:227]
  v_cvt_pk_bf16_f32 v107, v238, v239
  v_mfma_f32_4x4x4_16b_bf16 v[232:235], v[208:209], v[116:117], 0
  v_cvt_pk_bf16_f32 v108, v216, v217
  v_mfma_f32_4x4x4_16b_bf16 v[228:231], v[210:211], v[114:115], v[228:231]
  v_cvt_pk_bf16_f32 v109, v218, v219
  v_mfma_f32_4x4x4_16b_bf16 v[236:239], v[208:209], v[118:119], 0
  v_cvt_pk_bf16_f32 v110, v220, v221
  v_mfma_f32_4x4x4_16b_bf16 v[232:235], v[210:211], v[116:117], v[232:235]
  v_cvt_pk_bf16_f32 v111, v222, v223
  v_mfma_f32_4x4x4_16b_bf16 v[216:219], v[208:209], v[120:121], 0
  v_cvt_pk_bf16_f32 v112, v224, v225
  v_mfma_f32_4x4x4_16b_bf16 v[236:239], v[210:211], v[118:119], v[236:239]
  v_cvt_pk_bf16_f32 v113, v226, v227
  v_mfma_f32_4x4x4_16b_bf16 v[220:223], v[208:209], v[122:123], 0
  v_cvt_pk_bf16_f32 v114, v228, v229
  v_mfma_f32_4x4x4_16b_bf16 v[216:219], v[210:211], v[120:121], v[216:219]
  v_cvt_pk_bf16_f32 v115, v230, v231
  v_mfma_f32_4x4x4_16b_bf16 v[224:227], v[208:209], v[124:125], 0
  v_cvt_pk_bf16_f32 v116, v232, v233
  v_mfma_f32_4x4x4_16b_bf16 v[220:223], v[210:211], v[122:123], v[220:223]
  v_cvt_pk_bf16_f32 v117, v234, v235
  v_mfma_f32_4x4x4_16b_bf16 v[228:231], v[208:209], v[126:127], 0
  v_cvt_pk_bf16_f32 v118, v236, v237
  v_mfma_f32_4x4x4_16b_bf16 v[224:227], v[210:211], v[124:125], v[224:227]
  v_cvt_pk_bf16_f32 v119, v238, v239
  v_mfma_f32_4x4x4_16b_bf16 v[232:235], v[208:209], v[128:129], 0
  v_cvt_pk_bf16_f32 v120, v216, v217
  v_mfma_f32_4x4x4_16b_bf16 v[228:231], v[210:211], v[126:127], v[228:231]
  v_cvt_pk_bf16_f32 v121, v218, v219
  v_mfma_f32_4x4x4_16b_bf16 v[236:239], v[208:209], v[130:131], 0
  v_cvt_pk_bf16_f32 v122, v220, v221
  v_mfma_f32_4x4x4_16b_bf16 v[232:235], v[210:211], v[128:129], v[232:235]
  v_cvt_pk_bf16_f32 v123, v222, v223
  v_mfma_f32_4x4x4_16b_bf16 v[216:219], v[208:209], v[132:133], 0
  v_cvt_pk_bf16_f32 v124, v224, v225
  v_mfma_f32_4x4x4_16b_bf16 v[236:239], v[210:211], v[130:131], v[236:239]
  v_cvt_pk_bf16_f32 v125, v226, v227
  v_mfma_f32_4x4x4_16b_bf16 v[220:223], v[208:209], v[134:135], 0
  v_cvt_pk_bf16_f32 v126, v228, v229
  v_mfma_f32_4x4x4_16b_bf16 v[216:219], v[210:211], v[132:133], v[216:219]
  v_cvt_pk_bf16_f32 v127, v230, v231
  v_mfma_f32_4x4x4_16b_bf16 v[224:227], v[208:209], v[136:137], 0
  v_cvt_pk_bf16_f32 v128, v232, v233
  v_mfma_f32_4x4x4_16b_bf16 v[220:223], v[210:211], v[134:135], v[220:223]
  v_cvt_pk_bf16_f32 v129, v234, v235
  v_mfma_f32_4x4x4_16b_bf16 v[228:231], v[208:209], v[138:139], 0
  v_cvt_pk_bf16_f32 v130, v236, v237
  v_mfma_f32_4x4x4_16b_bf16 v[224:227], v[210:211], v[136:137], v[224:227]
  v_cvt_pk_bf16_f32 v131, v238, v239
  v_mfma_f32_4x4x4_16b_bf16 v[232:235], v[208:209], v[140:141], 0
  v_cvt_pk_bf16_f32 v132, v216, v217
  v_mfma_f32_4x4x4_16b_bf16 v[228:231], v[210:211], v[138:139], v[228:231]
  v_cvt_pk_bf16_f32 v133, v218, v219
  v_mfma_f32_4x4x4_16b_bf16 v[236:239], v[208:209], v[142:143], 0
  v_cvt_pk_bf16_f32 v134, v220, v221
  v_mfma_f32_4x4x4_16b_bf16 v[232:235], v[210:211], v[140:141], v[232:235]
  v_cvt_pk_bf16_f32 v135, v222, v223
  v_cvt_pk_bf16_f32 v136, v224, v225
  v_mfma_f32_4x4x4_16b_bf16 v[236:239], v[210:211], v[142:143], v[236:239]
  v_cvt_pk_bf16_f32 v137, v226, v227
  v_cvt_pk_bf16_f32 v138, v228, v229
  v_cvt_pk_bf16_f32 v139, v230, v231
  v_cvt_pk_bf16_f32 v140, v232, v233
  v_cvt_pk_bf16_f32 v141, v234, v235
  v_cvt_pk_bf16_f32 v142, v236, v237
  v_cvt_pk_bf16_f32 v143, v238, v239
  ds_write_b64 v255, v[60:61] offset:53280
  ds_write_b64 v255, v[64:65] offset:51712
  ds_write_b64 v255, v[68:69] offset:53312
  ds_write_b64 v255, v[72:73] offset:51744
  ds_write_b64 v255, v[76:77] offset:53344
  ds_write_b64 v255, v[80:81] offset:51776
  ds_write_b64 v255, v[84:85] offset:53376
  ds_write_b64 v255, v[88:89] offset:51808
  ds_write_b64 v255, v[92:93] offset:53408
  s_waitcnt lgkmcnt(0)
  s_barrier
  s_setprio 2
  s_branch L_first1
L_end:
  ds_read_b64_tr_b16 v[208:209], v250 offset:0
  ds_read_b64_tr_b16 v[210:211], v250 offset:1536
  ds_read_b64_tr_b16 v[212:213], v250 offset:32
  ds_read_b64_tr_b16 v[214:215], v250 offset:1568
  ds_read_b64_tr_b16 v[216:217], v250 offset:64
  ds_read_b64_tr_b16 v[218:219], v250 offset:1600
  ds_read_b64_tr_b16 v[220:221], v250 offset:96
  ds_read_b64_tr_b16 v[222:223], v250 offset:1632
  ds_read_b64_tr_b16 v[224:225], v250 offset:128
  ds_read_b64_tr_b16 v[226:227], v250 offset:1664
  ds_read_b64_tr_b16 v[228:229], v250 offset:160
  ds_read_b64_tr_b16 v[230:231], v250 offset:1696
  ds_read_b64_tr_b16 v[232:233], v250 offset:192
  ds_read_b64_tr_b16 v[234:235], v250 offset:1728
  ds_read_b64_tr_b16 v[236:237], v250 offset:224
  ds_read_b64_tr_b16 v[238:239], v250 offset:1760
  v_exp_f32 v245, v167
  v_exp_f32 v246, v168
  v_exp_f32 v247, v169
  v_exp_f32 v205, v170
  v_exp_f32 v206, v171
  v_cvt_pk_bf16_f32 v189, v244, v245
  v_cvt_pk_bf16_f32 v186, v246, v247
  v_cvt_pk_bf16_f32 v187, v205, v206
  v_or3_b32 v251, v251, v189, v186
  v_exp_f32 v244, v172
  v_exp_f32 v245, v173
  v_exp_f32 v246, v174
  v_exp_f32 v247, v175
  v_cvt_pk_bf16_f32 v190, v244, v245
  v_cvt_pk_bf16_f32 v191, v246, v247
  v_or3_b32 v251, v251, v187, v190
  v_bitop3_b32 v251, v251, v191, s57 bitop3:0xa8
  v_cmp_ne_u32 vcc, 0, v251
  s_waitcnt lgkmcnt(14)
  s_cbranch_vccnz L_stub8
L_chkret8:
  v_smfmac_f32_16x16x64_bf16 v[200:203], v[240:243], v[184:191], v204
  v_mfma_f32_16x16x32_bf16 v[0:3], v[208:211], v[184:187], v[0:3]
  v_mfma_f32_16x16x32_bf16 v[4:7], v[208:211], v[188:191], v[4:7]
  s_waitcnt lgkmcnt(12)
  ds_read_b64_tr_b16 v[208:209], v250 offset:256
  ds_read_b64_tr_b16 v[210:211], v250 offset:1792
  v_mfma_f32_16x16x32_bf16 v[8:11], v[212:215], v[184:187], v[8:11]
  v_mfma_f32_16x16x32_bf16 v[12:15], v[212:215], v[188:191], v[12:15]
  s_waitcnt lgkmcnt(12)
  ds_read_b64_tr_b16 v[212:213], v250 offset:288
  ds_read_b64_tr_b16 v[214:215], v250 offset:1824
  v_add_f32 v244, v200, v201
  v_mfma_f32_16x16x32_bf16 v[16:19], v[216:219], v[184:187], v[16:19]
  v_add_f32 v245, v202, v203
  v_cndmask_b32 v244, v244, v245, s[4:5]
  v_rcp_f32 v244, v244
  v_mfma_f32_16x16x32_bf16 v[20:23], v[216:219], v[188:191], v[20:23]
  s_waitcnt lgkmcnt(12)
  ds_read_b64_tr_b16 v[216:217], v250 offset:320
  ds_read_b64_tr_b16 v[218:219], v250 offset:1856
  v_mul_f32 v244, s100, v244
  v_mfma_f32_16x16x32_bf16 v[24:27], v[220:223], v[184:187], v[24:27]
  v_cvt_pk_bf16_f32 v251, v244, v244
  ds_write_b32 v254, v251 offset:384
  v_cvt_pk_bf16_f32 v0, v0, v1
  v_mfma_f32_16x16x32_bf16 v[28:31], v[220:223], v[188:191], v[28:31]
  s_waitcnt lgkmcnt(13)
  ds_read_b64_tr_b16 v[220:221], v250 offset:352
  ds_read_b64_tr_b16 v[222:223], v250 offset:1888
  v_cvt_pk_bf16_f32 v1, v2, v3
  v_mfma_f32_16x16x32_bf16 v[32:35], v[224:227], v[184:187], v[32:35]
  ds_write_b64 v255, v[0:1] offset:0
  v_cvt_pk_bf16_f32 v4, v4, v5
  v_cvt_pk_bf16_f32 v5, v6, v7
  v_mfma_f32_16x16x32_bf16 v[36:39], v[224:227], v[188:191], v[36:39]
  s_waitcnt lgkmcnt(14)
  ds_write_b64 v255, v[4:5] offset:1600
  v_cvt_pk_bf16_f32 v8, v8, v9
  v_cvt_pk_bf16_f32 v9, v10, v11
  v_mfma_f32_16x16x32_bf16 v[40:43], v[228:231], v[184:187], v[40:43]
  ds_write_b64 v255, v[8:9] offset:32
  v_cvt_pk_bf16_f32 v12, v12, v13
  v_cvt_pk_bf16_f32 v13, v14, v15
  v_mfma_f32_16x16x32_bf16 v[44:47], v[228:231], v[188:191], v[44:47]
  s_waitcnt lgkmcnt(14)
  ds_write_b64 v255, v[12:13] offset:1632
  v_cvt_pk_bf16_f32 v16, v16, v17
  v_cvt_pk_bf16_f32 v17, v18, v19
  v_mfma_f32_16x16x32_bf16 v[48:51], v[232:235], v[184:187], v[48:51]
  ds_write_b64 v255, v[16:17] offset:64
  v_cvt_pk_bf16_f32 v20, v20, v21
  v_cvt_pk_bf16_f32 v21, v22, v23
  v_mfma_f32_16x16x32_bf16 v[52:55], v[232:235], v[188:191], v[52:55]
  s_waitcnt lgkmcnt(14)
  ds_write_b64 v255, v[20:21] offset:1664
  v_cvt_pk_bf16_f32 v24, v24, v25
  v_cvt_pk_bf16_f32 v25, v26, v27
  v_mfma_f32_16x16x32_bf16 v[56:59], v[236:239], v[184:187], v[56:59]
  ds_write_b64 v255, v[24:25] offset:96
  v_cvt_pk_bf16_f32 v28, v28, v29
  v_cvt_pk_bf16_f32 v29, v30, v31
  v_mfma_f32_16x16x32_bf16 v[60:63], v[236:239], v[188:191], v[60:63]
  s_waitcnt lgkmcnt(14)
  ds_write_b64 v255, v[28:29] offset:1696
  v_cvt_pk_bf16_f32 v32, v32, v33
  v_cvt_pk_bf16_f32 v33, v34, v35
  v_mfma_f32_16x16x32_bf16 v[64:67], v[208:211], v[184:187], v[64:67]
  ds_write_b64 v255, v[32:33] offset:128
  s_waitcnt lgkmcnt(1)
  s_barrier
  v_cvt_pk_bf16_f32 v36, v36, v37
  v_mfma_f32_16x16x32_bf16 v[68:71], v[208:211], v[188:191], v[68:71]
  v_cvt_pk_bf16_f32 v37, v38, v39
  v_mfma_f32_16x16x32_bf16 v[72:75], v[212:215], v[184:187], v[72:75]
  ds_write_b64 v255, v[36:37] offset:1728
  v_cvt_pk_bf16_f32 v40, v40, v41
  v_cvt_pk_bf16_f32 v41, v42, v43
  v_mfma_f32_16x16x32_bf16 v[76:79], v[212:215], v[188:191], v[76:79]
  ds_write_b64 v255, v[40:41] offset:160
  v_cvt_pk_bf16_f32 v44, v44, v45
  v_cvt_pk_bf16_f32 v45, v46, v47
  v_mfma_f32_16x16x32_bf16 v[80:83], v[216:219], v[184:187], v[80:83]
  ds_write_b64 v255, v[44:45] offset:1760
  v_cvt_pk_bf16_f32 v48, v48, v49
  v_cvt_pk_bf16_f32 v49, v50, v51
  v_mfma_f32_16x16x32_bf16 v[84:87], v[216:219], v[188:191], v[84:87]
  ds_write_b64 v255, v[48:49] offset:192
  v_cvt_pk_bf16_f32 v52, v52, v53
  v_cvt_pk_bf16_f32 v53, v54, v55
  v_mfma_f32_16x16x32_bf16 v[88:91], v[220:223], v[184:187], v[88:91]
  ds_write_b64 v255, v[52:53] offset:1792
  v_cvt_pk_bf16_f32 v56, v56, v57
  v_cvt_pk_bf16_f32 v57, v58, v59
  v_mfma_f32_16x16x32_bf16 v[92:95], v[220:223], v[188:191], v[92:95]
  ds_write_b64 v255, v[56:57] offset:224
  v_cvt_pk_bf16_f32 v60, v60, v61
  v_cvt_pk_bf16_f32 v61, v62, v63
  v_cvt_pk_bf16_f32 v64, v64, v65
  v_cvt_pk_bf16_f32 v65, v66, v67
  ds_write_b64 v255, v[60:61] offset:1824
  ds_write_b64 v255, v[64:65] offset:256
  s_waitcnt lgkmcnt(1)
  s_barrier
  v_cvt_pk_bf16_f32 v68, v68, v69
  v_cvt_pk_bf16_f32 v69, v70, v71
  v_cvt_pk_bf16_f32 v72, v72, v73
  v_cvt_pk_bf16_f32 v73, v74, v75
  v_cvt_pk_bf16_f32 v76, v76, v77
  v_cvt_pk_bf16_f32 v77, v78, v79
  v_cvt_pk_bf16_f32 v80, v80, v81
  v_cvt_pk_bf16_f32 v81, v82, v83
  v_cvt_pk_bf16_f32 v84, v84, v85
  v_cvt_pk_bf16_f32 v85, v86, v87
  v_cvt_pk_bf16_f32 v88, v88, v89
  v_cvt_pk_bf16_f32 v89, v90, v91
  v_cvt_pk_bf16_f32 v92, v92, v93
  v_cvt_pk_bf16_f32 v93, v94, v95
  ds_write_b64 v255, v[68:69] offset:1856
  ds_write_b64 v255, v[72:73] offset:288
  ds_write_b64 v255, v[76:77] offset:1888
  ds_write_b64 v255, v[80:81] offset:320
  ds_write_b64 v255, v[84:85] offset:1920
  ds_write_b64 v255, v[88:89] offset:352
  ds_write_b64 v255, v[92:93] offset:1952
  s_waitcnt lgkmcnt(0)
  s_barrier
  s_endpgm
L_stub0:
  s_call_b64 s[58:59], L_fb0
  s_branch L_chkret0
L_stub1:
  s_call_b64 s[58:59], L_fb1
  s_branch L_chkret1
L_stub2:
  s_call_b64 s[58:59], L_fb0
  s_branch L_chkret2
L_stub3:
  s_call_b64 s[58:59], L_fb1
  s_branch L_chkret3
L_stub4:
  s_call_b64 s[58:59], L_fb0
  s_branch L_chkret4
L_stub5:
  s_call_b64 s[58:59], L_fb1
  s_branch L_chkret5
L_stub6:
  s_call_b64 s[58:59], L_fb1
  s_branch L_chkret6
L_stub7:
  s_call_b64 s[58:59], L_fb0
  s_branch L_chkret7
L_stub8:
  s_call_b64 s[58:59], L_fb1
  s_branch L_chkret8
L_fb0:
  v_max3_f32 v244, v144, v145, v146
  v_max3_f32 v244, v244, v147, v152
  v_max3_f32 v244, v244, v153, v154
  v_max_f32 v244, v244, v155
  v_max3_f32 v245, v148, v149, v150
  v_max3_f32 v245, v245, v151, v156
  v_max3_f32 v245, v245, v157, v158
  v_max_f32 v245, v245, v159
  s_nop 1
  v_permlane32_swap_b32 v244, v245
  v_max_f32 v244, v244, v245
  v_mov_b32 v245, v244
  s_nop 1
  v_permlane16_swap_b32 v244, v245
  v_max_f32 v244, v244, v245
  v_mov_b32 v245, v244
  s_nop 1
  v_permlane32_swap_b32 v244, v245
  v_add_f32 v244, 0x41800000, v244
  v_add_f32 v245, 0x41800000, v245
  v_max_f32 v244, 0, v244
  v_max_f32 v245, 0, v245
  v_exp_f32 v246, -v244
  v_exp_f32 v247, -v245
  s_nop 0
  v_mul_f32 v0, v0, v246
  v_mul_f32 v1, v1, v246
  v_mul_f32 v2, v2, v246
  v_mul_f32 v3, v3, v246
  v_mul_f32 v4, v4, v247
  v_mul_f32 v5, v5, v247
  v_mul_f32 v6, v6, v247
  v_mul_f32 v7, v7, v247
  v_mul_f32 v8, v8, v246
  v_mul_f32 v9, v9, v246
  v_mul_f32 v10, v10, v246
  v_mul_f32 v11, v11, v246
  v_mul_f32 v12, v12, v247
  v_mul_f32 v13, v13, v247
  v_mul_f32 v14, v14, v247
  v_mul_f32 v15, v15, v247
  v_mul_f32 v16, v16, v246
  v_mul_f32 v17, v17, v246
  v_mul_f32 v18, v18, v246
  v_mul_f32 v19, v19, v246
  v_mul_f32 v20, v20, v247
  v_mul_f32 v21, v21, v247
  v_mul_f32 v22, v22, v247
  v_mul_f32 v23, v23, v247
  v_mul_f32 v24, v24, v246
  v_mul_f32 v25, v25, v246
  v_mul_f32 v26, v26, v246
  v_mul_f32 v27, v27, v246
  v_mul_f32 v28, v28, v247
  v_mul_f32 v29, v29, v247
  v_mul_f32 v30, v30, v247
  v_mul_f32 v31, v31, v247
  v_mul_f32 v32, v32, v246
  v_mul_f32 v33, v33, v246
  v_mul_f32 v34, v34, v246
  v_mul_f32 v35, v35, v246
  v_mul_f32 v36, v36, v247
  v_mul_f32 v37, v37, v247
  v_mul_f32 v38, v38, v247
  v_mul_f32 v39, v39, v247
  v_mul_f32 v40, v40, v246
  v_mul_f32 v41, v41, v246
  v_mul_f32 v42, v42, v246
  v_mul_f32 v43, v43, v246
  v_mul_f32 v44, v44, v247
  v_mul_f32 v45, v45, v247
  v_mul_f32 v46, v46, v247
  v_mul_f32 v47, v47, v247
  v_mul_f32 v48, v48, v246
  v_mul_f32 v49, v49, v246
  v_mul_f32 v50, v50, v246
  v_mul_f32 v51, v51, v246
  v_mul_f32 v52, v52, v247
  v_mul_f32 v53, v53, v247
  v_mul_f32 v54, v54, v247
  v_mul_f32 v55, v55, v247
  v_mul_f32 v56, v56, v246
  v_mul_f32 v57, v57, v246
  v_mul_f32 v58, v58, v246
  v_mul_f32 v59, v59, v246
  v_mul_f32 v60, v60, v247
  v_mul_f32 v61, v61, v247
  v_mul_f32 v62, v62, v247
  v_mul_f32 v63, v63, v247
  v_mul_f32 v64, v64, v246
  v_mul_f32 v65, v65, v246
  v_mul_f32 v66, v66, v246
  v_mul_f32 v67, v67, v246
  v_mul_f32 v68, v68, v247
  v_mul_f32 v69, v69, v247
  v_mul_f32 v70, v70, v247
  v_mul_f32 v71, v71, v247
  v_mul_f32 v72, v72, v246
  v_mul_f32 v73, v73, v246
  v_mul_f32 v74, v74, v246
  v_mul_f32 v75, v75, v246
  v_mul_f32 v76, v76, v247
  v_mul_f32 v77, v77, v247
  v_mul_f32 v78, v78, v247
  v_mul_f32 v79, v79, v247
  v_mul_f32 v80, v80, v246
  v_mul_f32 v81, v81, v246
  v_mul_f32 v82, v82, v246
  v_mul_f32 v83, v83, v246
  v_mul_f32 v84, v84, v247
  v_mul_f32 v85, v85, v247
  v_mul_f32 v86, v86, v247
  v_mul_f32 v87, v87, v247
  v_mul_f32 v88, v88, v246
  v_mul_f32 v89, v89, v246
  v_mul_f32 v90, v90, v246
  v_mul_f32 v91, v91, v246
  v_mul_f32 v92, v92, v247
  v_mul_f32 v93, v93, v247
  v_mul_f32 v94, v94, v247
  v_mul_f32 v95, v95, v247
  v_mul_f32 v200, v200, v246
  v_mul_f32 v201, v201, v246
  v_mul_f32 v202, v202, v247
  v_mul_f32 v203, v203, v247
  v_sub_f32 v144, v144, v244
  v_sub_f32 v145, v145, v244
  v_sub_f32 v146, v146, v244
  v_sub_f32 v147, v147, v244
  v_sub_f32 v148, v148, v245
  v_sub_f32 v149, v149, v245
  v_sub_f32 v150, v150, v245
  v_sub_f32 v151, v151, v245
  v_sub_f32 v152, v152, v244
  v_sub_f32 v153, v153, v244
  v_sub_f32 v154, v154, v244
  v_sub_f32 v155, v155, v244
  v_sub_f32 v156, v156, v245
  v_sub_f32 v157, v157, v245
  v_sub_f32 v158, v158, v245
  v_sub_f32 v159, v159, v245
  v_sub_f32 v160, v160, v244
  v_sub_f32 v161, v161, v244
  v_sub_f32 v162, v162, v244
  v_sub_f32 v163, v163, v244
  v_sub_f32 v164, v164, v245
  v_sub_f32 v165, v165, v245
  v_sub_f32 v166, v166, v245
  v_sub_f32 v167, v167, v245
  v_sub_f32 v168, v168, v244
  v_sub_f32 v169, v169, v244
  v_sub_f32 v170, v170, v244
  v_sub_f32 v171, v171, v244
  v_sub_f32 v172, v172, v245
  v_sub_f32 v173, v173, v245
  v_sub_f32 v174, v174, v245
  v_sub_f32 v175, v175, v245
  v_sub_f32 v192, v192, v244
  v_sub_f32 v193, v193, v244
  v_sub_f32 v194, v194, v244
  v_sub_f32 v195, v195, v244
  v_sub_f32 v196, v196, v245
  v_sub_f32 v197, v197, v245
  v_sub_f32 v198, v198, v245
  v_sub_f32 v199, v199, v245
  v_exp_f32 v246, v144
  v_exp_f32 v247, v145
  s_nop 0
  v_cvt_pk_bf16_f32 v176, v246, v247
  v_exp_f32 v246, v146
  v_exp_f32 v247, v147
  s_nop 0
  v_cvt_pk_bf16_f32 v177, v246, v247
  v_exp_f32 v246, v148
  v_exp_f32 v247, v149
  s_nop 0
  v_cvt_pk_bf16_f32 v180, v246, v247
  v_exp_f32 v246, v150
  v_exp_f32 v247, v151
  s_nop 0
  v_cvt_pk_bf16_f32 v181, v246, v247
  v_exp_f32 v246, v152
  v_exp_f32 v247, v153
  s_nop 0
  v_cvt_pk_bf16_f32 v178, v246, v247
  v_exp_f32 v246, v154
  v_exp_f32 v247, v155
  s_nop 0
  v_cvt_pk_bf16_f32 v179, v246, v247
  v_exp_f32 v246, v156
  v_exp_f32 v247, v157
  s_nop 0
  v_cvt_pk_bf16_f32 v182, v246, v247
  v_exp_f32 v246, v158
  v_exp_f32 v247, v159
  s_nop 0
  v_cvt_pk_bf16_f32 v183, v246, v247
  s_setpc_b64 s[58:59]
L_fb1:
  v_max3_f32 v244, v160, v161, v162
  v_max3_f32 v244, v244, v163, v168
  v_max3_f32 v244, v244, v169, v170
  v_max_f32 v244, v244, v171
  v_max3_f32 v245, v164, v165, v166
  v_max3_f32 v245, v245, v167, v172
  v_max3_f32 v245, v245, v173, v174
  v_max_f32 v245, v245, v175
  s_nop 1
  v_permlane32_swap_b32 v244, v245
  v_max_f32 v244, v244, v245
  v_mov_b32 v245, v244
  s_nop 1
  v_permlane16_swap_b32 v244, v245
  v_max_f32 v244, v244, v245
  v_mov_b32 v245, v244
  s_nop 1
  v_permlane32_swap_b32 v244, v245
  v_add_f32 v244, 0x41800000, v244
  v_add_f32 v245, 0x41800000, v245
  v_max_f32 v244, 0, v244
  v_max_f32 v245, 0, v245
  v_exp_f32 v246, -v244
  v_exp_f32 v247, -v245
  s_nop 0
  v_mul_f32 v0, v0, v246
  v_mul_f32 v1, v1, v246
  v_mul_f32 v2, v2, v246
  v_mul_f32 v3, v3, v246
  v_mul_f32 v4, v4, v247
  v_mul_f32 v5, v5, v247
  v_mul_f32 v6, v6, v247
  v_mul_f32 v7, v7, v247
  v_mul_f32 v8, v8, v246
  v_mul_f32 v9, v9, v246
  v_mul_f32 v10, v10, v246
  v_mul_f32 v11, v11, v246
  v_mul_f32 v12, v12, v247
  v_mul_f32 v13, v13, v247
  v_mul_f32 v14, v14, v247
  v_mul_f32 v15, v15, v247
  v_mul_f32 v16, v16, v246
  v_mul_f32 v17, v17, v246
  v_mul_f32 v18, v18, v246
  v_mul_f32 v19, v19, v246
  v_mul_f32 v20, v20, v247
  v_mul_f32 v21, v21, v247
  v_mul_f32 v22, v22, v247
  v_mul_f32 v23, v23, v247
  v_mul_f32 v24, v24, v246
  v_mul_f32 v25, v25, v246
  v_mul_f32 v26, v26, v246
  v_mul_f32 v27, v27, v246
  v_mul_f32 v28, v28, v247
  v_mul_f32 v29, v29, v247
  v_mul_f32 v30, v30, v247
  v_mul_f32 v31, v31, v247
  v_mul_f32 v32, v32, v246
  v_mul_f32 v33, v33, v246
  v_mul_f32 v34, v34, v246
  v_mul_f32 v35, v35, v246
  v_mul_f32 v36, v36, v247
  v_mul_f32 v37, v37, v247
  v_mul_f32 v38, v38, v247
  v_mul_f32 v39, v39, v247
  v_mul_f32 v40, v40, v246
  v_mul_f32 v41, v41, v246
  v_mul_f32 v42, v42, v246
  v_mul_f32 v43, v43, v246
  v_mul_f32 v44, v44, v247
  v_mul_f32 v45, v45, v247
  v_mul_f32 v46, v46, v247
  v_mul_f32 v47, v47, v247
  v_mul_f32 v48, v48, v246
  v_mul_f32 v49, v49, v246
  v_mul_f32 v50, v50, v246
  v_mul_f32 v51, v51, v246
  v_mul_f32 v52, v52, v247
  v_mul_f32 v53, v53, v247
  v_mul_f32 v54, v54, v247
  v_mul_f32 v55, v55, v247
  v_mul_f32 v56, v56, v246
  v_mul_f32 v57, v57, v246
  v_mul_f32 v58, v58, v246
  v_mul_f32 v59, v59, v246
  v_mul_f32 v60, v60, v247
  v_mul_f32 v61, v61, v247
  v_mul_f32 v62, v62, v247
  v_mul_f32 v63, v63, v247
  v_mul_f32 v64, v64, v246
  v_mul_f32 v65, v65, v246
  v_mul_f32 v66, v66, v246
  v_mul_f32 v67, v67, v246
  v_mul_f32 v68, v68, v247
  v_mul_f32 v69, v69, v247
  v_mul_f32 v70, v70, v247
  v_mul_f32 v71, v71, v247
  v_mul_f32 v72, v72, v246
  v_mul_f32 v73, v73, v246
  v_mul_f32 v74, v74, v246
  v_mul_f32 v75, v75, v246
  v_mul_f32 v76, v76, v247
  v_mul_f32 v77, v77, v247
  v_mul_f32 v78, v78, v247
  v_mul_f32 v79, v79, v247
  v_mul_f32 v80, v80, v246
  v_mul_f32 v81, v81, v246
  v_mul_f32 v82, v82, v246
  v_mul_f32 v83, v83, v246
  v_mul_f32 v84, v84, v247
  v_mul_f32 v85, v85, v247
  v_mul_f32 v86, v86, v247
  v_mul_f32 v87, v87, v247
  v_mul_f32 v88, v88, v246
  v_mul_f32 v89, v89, v246
  v_mul_f32 v90, v90, v246
  v_mul_f32 v91, v91, v246
  v_mul_f32 v92, v92, v247
  v_mul_f32 v93, v93, v247
  v_mul_f32 v94, v94, v247
  v_mul_f32 v95, v95, v247
  v_mul_f32 v200, v200, v246
  v_mul_f32 v201, v201, v246
  v_mul_f32 v202, v202, v247
  v_mul_f32 v203, v203, v247
  v_sub_f32 v160, v160, v244
  v_sub_f32 v161, v161, v244
  v_sub_f32 v162, v162, v244
  v_sub_f32 v163, v163, v244
  v_sub_f32 v164, v164, v245
  v_sub_f32 v165, v165, v245
  v_sub_f32 v166, v166, v245
  v_sub_f32 v167, v167, v245
  v_sub_f32 v168, v168, v244
  v_sub_f32 v169, v169, v244
  v_sub_f32 v170, v170, v244
  v_sub_f32 v171, v171, v244
  v_sub_f32 v172, v172, v245
  v_sub_f32 v173, v173, v245
  v_sub_f32 v174, v174, v245
  v_sub_f32 v175, v175, v245
  v_sub_f32 v144, v144, v244
  v_sub_f32 v145, v145, v244
  v_sub_f32 v146, v146, v244
  v_sub_f32 v147, v147, v244
  v_sub_f32 v148, v148, v245
  v_sub_f32 v149, v149, v245
  v_sub_f32 v150, v150, v245
  v_sub_f32 v151, v151, v245
  v_sub_f32 v152, v152, v244
  v_sub_f32 v153, v153, v244
  v_sub_f32 v154, v154, v244
  v_sub_f32 v155, v155, v244
  v_sub_f32 v156, v156, v245
  v_sub_f32 v157, v157, v245
  v_sub_f32 v158, v158, v245
  v_sub_f32 v159, v159, v245
  v_sub_f32 v192, v192, v244
  v_sub_f32 v193, v193, v244
  v_sub_f32 v194, v194, v244
  v_sub_f32 v195, v195, v244
  v_sub_f32 v196, v196, v245
  v_sub_f32 v197, v197, v245
  v_sub_f32 v198, v198, v245
  v_sub_f32 v199, v199, v245
  v_exp_f32 v246, v160
  v_exp_f32 v247, v161
  s_nop 0
  v_cvt_pk_bf16_f32 v184, v246, v247
  v_exp_f32 v246, v162
  v_exp_f32 v247, v163
  s_nop 0
  v_cvt_pk_bf16_f32 v185, v246, v247
  v_exp_f32 v246, v164
  v_exp_f32 v247, v165
  s_nop 0
  v_cvt_pk_bf16_f32 v188, v246, v247
  v_exp_f32 v246, v166
  v_exp_f32 v247, v167
  s_nop 0
  v_cvt_pk_bf16_f32 v189, v246, v247
  v_exp_f32 v246, v168
  v_exp_f32 v247, v169
  s_nop 0
  v_cvt_pk_bf16_f32 v186, v246, v247
  v_exp_f32 v246, v170
  v_exp_f32 v247, v171
  s_nop 0
  v_cvt_pk_bf16_f32 v187, v246, v247
  v_exp_f32 v246, v172
  v_exp_f32 v247, v173
  s_nop 0
  v_cvt_pk_bf16_f32 v190, v246, v247
  v_exp_f32 v246, v174
  v_exp_f32 v247, v175
  s_nop 0
  v_cvt_pk_bf16_f32 v191, v246, v247
  s_setpc_b64 s[58:59]
L_helper2:
  s_add_u32 s8, s36, s60
  s_addc_u32 s9, s37, 0
  s_mov_b32 s10, 786432
  s_mov_b32 s11, 0x20000
  s_add_u32 s20, s42, s60
  s_addc_u32 s21, s43, 0
  s_mov_b32 s22, 786432
  s_mov_b32 s23, 0x20000
  s_add_u32 s24, s44, s60
  s_addc_u32 s25, s45, 0
  s_mov_b32 s26, 786432
  s_mov_b32 s27, 0x20000
  s_add_u32 s32, s50, s60
  s_addc_u32 s33, s51, 0
  s_mov_b32 s34, 786432
  s_mov_b32 s35, 0x20000
  s_lshl_b32 s61, s52, 14
  s_add_u32 s28, s46, s61
  s_addc_u32 s29, s47, 0
  s_mov_b32 s30, 16384
  s_mov_b32 s31, 0x20000
  s_lshr_b32 s62, s52, 1
  s_lshl_b32 s62, s62, 2
  s_load_dword s65, s[48:49], s62
  v_lshrrev_b32 v9, 3, v8
  v_and_b32 v3, 7, v8
  v_lshlrev_b32 v3, 4, v3
  v_mul_u32_u24 v1, 384, v9
  v_add_u32 v1, v1, v3
  s_add_u32 s63, s54, s55
  s_mul_i32 s68, s63, 12288
  s_sub_u32 s64, 63, s63
  s_mul_i32 s69, s64, 12288
  s_add_u32 s76, s68, 6144
  s_add_u32 s77, s69, 6144
  s_lshl_b32 s60, s63, 8
  s_lshl_b32 s61, s64, 8
  s_add_u32 s58, s63, 3
  s_sub_u32 s95, 63, s54
  s_mul_i32 s95, s95, 12288
  s_add_u32 s95, s95, s101
  v_lshlrev_b32 v10, 3, v9
  s_mul_i32 s96, s55, 12864
  s_add_u32 s64, s96, 60928
  s_add_u32 s96, s96, 112384
  v_add_u32 v2, s64, v1
  s_mov_b32 s74, 0x3dd53b95
  s_mov_b32 s75, 0xffff0000
  s_mov_b32 s78, 384
  s_mov_b32 s92, 0x01000100
  s_mov_b32 s93, 0x03020302
  s_mov_b32 s59, 0
  s_waitcnt lgkmcnt(0)
  s_lshl_b32 s63, s65, 16
  s_and_b32 s65, s65, 0xffff0000
  s_bitcmp1_b32 s52, 0
  s_cselect_b32 s63, s65, s63
  v_mov_b32 v14, s63
  v_mul_f32 v14, 0x3fb8aa3b, v14
  v_exp_f32 v14, -v14
  s_nop 0
  v_add_f32 v14, 1.0, v14
  v_rcp_f32 v14, v14
  s_nop 0
  v_cvt_pk_bf16_f32 v14, v14, v14
  v_lshlrev_b32 v14, 16, v14
  s_nop 0
  v_readfirstlane_b32 s56, v14
  s_add_u32 m0, s100, 62080
  s_mov_b32 s67, s66
  s_add_u32 s66, s66, s73
  buffer_load_dwordx4 v56, s[12:15], s66 offen offset:0  lds
  buffer_load_dwordx4 v56, s[12:15], s66 offen offset:1024  lds
  buffer_load_dwordx4 v56, s[12:15], s66 offen offset:2048  lds
  s_add_u32 m0, s100, 0
  s_nop 0
  buffer_load_dwordx4 v56, s[16:19], s67 offen offset:0  lds
  buffer_load_dwordx4 v56, s[16:19], s67 offen offset:1024  lds
  buffer_load_dwordx4 v56, s[16:19], s67 offen offset:2048  lds
  s_waitcnt vmcnt(7)
  s_barrier
  s_add_u32 m0, s100, 74496
  s_mov_b32 s67, s66
  s_add_u32 s66, s66, s73
  buffer_load_dwordx4 v56, s[12:15], s66 offen offset:0  lds
  buffer_load_dwordx4 v56, s[12:15], s66 offen offset:1024  lds
  buffer_load_dwordx4 v56, s[12:15], s66 offen offset:2048  lds
  s_add_u32 m0, s100, 12416
  s_nop 0
  buffer_load_dwordx4 v56, s[16:19], s67 offen offset:0  lds
  buffer_load_dwordx4 v56, s[16:19], s67 offen offset:1024  lds
  buffer_load_dwordx4 v56, s[16:19], s67 offen offset:2048  lds
  buffer_load_dwordx2 v[16:17], v6, s[4:7], 0 offen offset:60
  v_add_u32 v6, 49152, v6
  buffer_load_dwordx2 v[232:233], v10, s[28:31], s60 offen offset:0
  buffer_load_dwordx2 v[234:235], v10, s[28:31], s60 offen offset:64
  buffer_load_dwordx2 v[236:237], v10, s[28:31], s60 offen offset:128
  buffer_load_dwordx2 v[238:239], v10, s[28:31], s60 offen offset:192
  buffer_load_dwordx2 v[240:241], v10, s[28:31], s61 offen offset:0
  buffer_load_dwordx2 v[242:243], v10, s[28:31], s61 offen offset:64
  buffer_load_dwordx2 v[244:245], v10, s[28:31], s61 offen offset:128
  buffer_load_dwordx2 v[246:247], v10, s[28:31], s61 offen offset:192
  s_waitcnt vmcnt(15)
  s_barrier
  v_and_b32 v0, 16, v3
  s_mov_b32 s62, 0xffff
  v_lshlrev_b32 v0, v0, s62
  v_bfe_i32 v8, v3, 5, 1
  v_bfi_b32 v57, v8, 0, v0
  v_and_b32 v0, v8, v0
L_var0:
  s_add_u32 m0, s100, 86912
  s_mov_b32 s67, s66
  s_add_u32 s66, s66, s73
  buffer_load_dwordx4 v56, s[12:15], s66 offen offset:0  lds
  buffer_load_dwordx4 v56, s[12:15], s66 offen offset:1024  lds
  buffer_load_dwordx4 v56, s[12:15], s66 offen offset:2048  lds
  s_add_u32 m0, s100, 24832
  s_nop 0
  buffer_load_dwordx4 v56, s[16:19], s67 offen offset:0  lds
  buffer_load_dwordx4 v56, s[16:19], s67 offen offset:1024  lds
  buffer_load_dwordx4 v56, s[16:19], s67 offen offset:2048  lds
  s_add_u32 m0, s100, 99328
  s_mov_b32 s67, s66
  s_add_u32 s66, s66, s73
  buffer_load_dwordx4 v56, s[12:15], s66 offen offset:0  lds
  buffer_load_dwordx4 v56, s[12:15], s66 offen offset:1024  lds
  buffer_load_dwordx4 v56, s[12:15], s66 offen offset:2048  lds
  s_waitcnt vmcnt(18)
  s_waitcnt lgkmcnt(0)
  s_barrier
  s_add_u32 m0, s100, 37248
  s_nop 0
  buffer_load_dwordx4 v56, s[16:19], s67 offen offset:0  lds
  s_waitcnt vmcnt(10)
  v_lshl_or_b32 v32, v233, 16, v232
  buffer_load_dwordx4 v56, s[16:19], s67 offen offset:1024  lds
  v_lshl_or_b32 v33, v235, 16, v234
  buffer_load_dwordx4 v56, s[16:19], s67 offen offset:2048  lds
  v_lshl_or_b32 v34, v237, 16, v236
  s_add_u32 m0, s100, 62080
  s_mov_b32 s67, s66
  s_add_u32 s66, s66, s73
  buffer_load_dwordx4 v56, s[12:15], s66 offen offset:0  lds
  v_lshl_or_b32 v35, v239, 16, v238
  buffer_load_dwordx4 v56, s[12:15], s66 offen offset:1024  lds
  v_lshl_or_b32 v36, v241, 16, v240
  buffer_load_dwordx4 v56, s[12:15], s66 offen offset:2048  lds
  v_lshl_or_b32 v37, v243, 16, v242
  s_add_u32 m0, s100, 49664
  s_nop 0
  buffer_load_dwordx4 v56, s[16:19], s67 offen offset:0  lds
  v_lshl_or_b32 v38, v245, 16, v244
  buffer_load_dwordx4 v56, s[16:19], s67 offen offset:1024  lds
  v_lshl_or_b32 v39, v247, 16, v246
  buffer_load_dwordx4 v56, s[16:19], s67 offen offset:2048  lds
  s_waitcnt vmcnt(12)
  s_waitcnt lgkmcnt(0)
  s_barrier
  v_and_b32 v4, 0xffff, v32
  v_mad_u32_u24 v4, v4, s78, v3
  buffer_load_dwordx4 v[64:67], v4, s[20:23], 0 offen offset:0
  buffer_load_dwordx4 v[72:75], v4, s[20:23], 0 offen offset:128
  buffer_load_dwordx4 v[80:83], v4, s[20:23], 0 offen offset:256
  v_lshrrev_b32 v4, 16, v32
  v_mad_u32_u24 v4, v4, s78, v3
  buffer_load_dwordx4 v[68:71], v4, s[20:23], 0 offen offset:0
  buffer_load_dwordx4 v[76:79], v4, s[20:23], 0 offen offset:128
  buffer_load_dwordx4 v[84:87], v4, s[20:23], 0 offen offset:256
  s_waitcnt vmcnt(12)
  s_waitcnt lgkmcnt(0)
  s_barrier
  s_add_u32 m0, s100, 74496
  s_mov_b32 s67, s66
  s_add_u32 s66, s66, s73
  buffer_load_dwordx4 v56, s[12:15], s66 offen offset:0  lds
  buffer_load_dwordx4 v56, s[12:15], s66 offen offset:1024  lds
  buffer_load_dwordx4 v56, s[12:15], s66 offen offset:2048  lds
  s_add_u32 m0, s100, 0
  s_nop 0
  buffer_load_dwordx4 v56, s[16:19], s67 offen offset:0  lds
  buffer_load_dwordx4 v56, s[16:19], s67 offen offset:1024  lds
  buffer_load_dwordx4 v56, s[16:19], s67 offen offset:2048  lds
  s_add_u32 m0, s100, 86912
  s_mov_b32 s67, s66
  s_add_u32 s66, s66, s73
  buffer_load_dwordx4 v56, s[12:15], s66 offen offset:0  lds
  buffer_load_dwordx4 v56, s[12:15], s66 offen offset:1024  lds
  buffer_load_dwordx4 v56, s[12:15], s66 offen offset:2048  lds
  s_add_u32 m0, s100, 12416
  s_nop 0
  buffer_load_dwordx4 v56, s[16:19], s67 offen offset:0  lds
  buffer_load_dwordx4 v56, s[16:19], s67 offen offset:1024  lds
  buffer_load_dwordx4 v56, s[16:19], s67 offen offset:2048  lds
  s_waitcnt vmcnt(18)
  s_waitcnt lgkmcnt(0)
  s_barrier
  buffer_load_dwordx2 v[16:17], v6, s[4:7], 0 offen offset:60
  v_add_u32 v6, 49152, v6
  v_and_b32 v4, 0xffff, v33
  v_mad_u32_u24 v4, v4, s78, v3
  buffer_load_dwordx4 v[88:91], v4, s[20:23], 0 offen offset:0
  buffer_load_dwordx4 v[96:99], v4, s[20:23], 0 offen offset:128
  buffer_load_dwordx4 v[104:107], v4, s[20:23], 0 offen offset:256
  s_waitcnt vmcnt(10)
  s_waitcnt lgkmcnt(0)
  s_barrier
  ds_read_b128 v[20:23], v2 offset:51456
  ds_read_b128 v[24:27], v2 offset:51584
  ds_read_b128 v[28:31], v2 offset:51712
  s_waitcnt lgkmcnt(0)
  s_setprio 3
  v_mfma_f32_4x4x4_16b_bf16 v[8:11], v[20:21], v[64:65], 0
  v_mfma_f32_4x4x4_16b_bf16 v[48:51], v[20:21], v[68:69], 0
  v_mfma_f32_4x4x4_16b_bf16 v[12:15], v[22:23], v[66:67], 0
  v_mfma_f32_4x4x4_16b_bf16 v[52:55], v[22:23], v[70:71], 0
  v_mfma_f32_4x4x4_16b_bf16 v[8:11], v[24:25], v[72:73], v[8:11]
  v_mfma_f32_4x4x4_16b_bf16 v[48:51], v[24:25], v[76:77], v[48:51]
  v_mfma_f32_4x4x4_16b_bf16 v[12:15], v[26:27], v[74:75], v[12:15]
  v_mfma_f32_4x4x4_16b_bf16 v[52:55], v[26:27], v[78:79], v[52:55]
  v_mfma_f32_4x4x4_16b_bf16 v[8:11], v[28:29], v[80:81], v[8:11]
  v_mfma_f32_4x4x4_16b_bf16 v[48:51], v[28:29], v[84:85], v[48:51]
  v_mfma_f32_4x4x4_16b_bf16 v[12:15], v[30:31], v[82:83], v[12:15]
  v_mfma_f32_4x4x4_16b_bf16 v[52:55], v[30:31], v[86:87], v[52:55]
  s_setprio 0
  s_add_u32 m0, s100, 99328
  s_mov_b32 s67, s66
  s_add_u32 s66, s66, s73
  buffer_load_dwordx4 v56, s[12:15], s66 offen offset:0  lds
  buffer_load_dwordx4 v56, s[12:15], s66 offen offset:1024  lds
  buffer_load_dwordx4 v56, s[12:15], s66 offen offset:2048  lds
  s_nop 1
  s_add_u32 m0, s100, 24832
  s_nop 0
  buffer_load_dwordx4 v56, s[16:19], s67 offen offset:0  lds
  v_mov_b32_dpp v64, v8 quad_perm:[0,0,0,0] row_mask:0xf bank_mask:0xf
  v_mov_b32_dpp v65, v48 quad_perm:[0,0,0,0] row_mask:0xf bank_mask:0xf
  buffer_load_dwordx4 v56, s[16:19], s67 offen offset:1024  lds
  v_add_f32_dpp v64, v9, v64 quad_perm:[1,1,1,1] row_mask:0xf bank_mask:0xf
  v_add_f32_dpp v65, v49, v65 quad_perm:[1,1,1,1] row_mask:0xf bank_mask:0xf
  buffer_load_dwordx4 v56, s[16:19], s67 offen offset:2048  lds
  v_add_f32_dpp v64, v10, v64 quad_perm:[2,2,2,2] row_mask:0xf bank_mask:0xf
  v_add_f32_dpp v65, v50, v65 quad_perm:[2,2,2,2] row_mask:0xf bank_mask:0xf
  s_add_u32 m0, s100, 62080
  s_mov_b32 s67, s66
  s_add_u32 s66, s66, s73
  buffer_load_dwordx4 v56, s[12:15], s66 offen offset:0  lds
  v_add_f32_dpp v64, v11, v64 quad_perm:[3,3,3,3] row_mask:0xf bank_mask:0xf
  buffer_load_dwordx4 v56, s[12:15], s66 offen offset:1024  lds
  v_add_f32_dpp v65, v51, v65 quad_perm:[3,3,3,3] row_mask:0xf bank_mask:0xf
  v_add_f32_dpp v64, v12, v64 quad_perm:[0,0,0,0] row_mask:0xf bank_mask:0xf
  buffer_load_dwordx4 v56, s[12:15], s66 offen offset:2048  lds
  v_add_f32_dpp v65, v52, v65 quad_perm:[0,0,0,0] row_mask:0xf bank_mask:0xf
  v_add_f32_dpp v64, v13, v64 quad_perm:[1,1,1,1] row_mask:0xf bank_mask:0xf
  s_add_u32 m0, s100, 37248
  s_nop 0
  buffer_load_dwordx4 v56, s[16:19], s67 offen offset:0  lds
  v_add_f32_dpp v65, v53, v65 quad_perm:[1,1,1,1] row_mask:0xf bank_mask:0xf
  v_add_f32_dpp v64, v14, v64 quad_perm:[2,2,2,2] row_mask:0xf bank_mask:0xf
  buffer_load_dwordx4 v56, s[16:19], s67 offen offset:1024  lds
  v_add_f32_dpp v65, v54, v65 quad_perm:[2,2,2,2] row_mask:0xf bank_mask:0xf
  v_add_f32_dpp v64, v15, v64 quad_perm:[3,3,3,3] row_mask:0xf bank_mask:0xf
  buffer_load_dwordx4 v56, s[16:19], s67 offen offset:2048  lds
  v_add_f32_dpp v65, v55, v65 quad_perm:[3,3,3,3] row_mask:0xf bank_mask:0xf
  s_waitcnt vmcnt(16)
  s_waitcnt lgkmcnt(0)
  s_barrier
  v_lshrrev_b32 v4, 16, v33
  v_mad_u32_u24 v4, v4, s78, v3
  buffer_load_dwordx4 v[92:95], v4, s[20:23], 0 offen offset:0
  v_add_f32_dpp v64, v64, v64 row_half_mirror row_mask:0xf bank_mask:0xf
  v_add_f32_dpp v65, v65, v65 row_half_mirror row_mask:0xf bank_mask:0xf
  v_max_f32 v66, v64, v65
  buffer_load_dwordx4 v[100:103], v4, s[20:23], 0 offen offset:128
  v_sub_f32 v64, v64, v66
  v_sub_f32 v65, v65, v66
  v_exp_f32 v64, v64
  buffer_load_dwordx4 v[108:111], v4, s[20:23], 0 offen offset:256
  v_exp_f32 v65, v65
  v_and_b32 v4, 0xffff, v34
  v_mad_u32_u24 v4, v4, s78, v3
  buffer_load_dwordx4 v[112:115], v4, s[20:23], 0 offen offset:0
  s_nop 0
  v_add_f32 v66, v64, v65
  v_rcp_f32 v66, v66
  buffer_load_dwordx4 v[120:123], v4, s[20:23], 0 offen offset:128
  s_nop 0
  v_mul_f32 v66, s56, v66
  v_mul_f32 v64, v64, v66
  buffer_load_dwordx4 v[128:131], v4, s[20:23], 0 offen offset:256
  v_mul_f32 v65, v65, v66
  v_cvt_pk_bf16_f32 v40, v64, v65
  s_waitcnt vmcnt(12)
  s_waitcnt lgkmcnt(0)
  s_barrier
  s_add_u32 m0, s100, 74496
  s_mov_b32 s67, s66
  s_add_u32 s66, s66, s73
  buffer_load_dwordx4 v56, s[12:15], s66 offen offset:0  lds
  buffer_load_dwordx4 v56, s[12:15], s66 offen offset:1024  lds
  buffer_load_dwordx4 v56, s[12:15], s66 offen offset:2048  lds
  s_add_u32 m0, s100, 49664
  s_nop 0
  buffer_load_dwordx4 v56, s[16:19], s67 offen offset:0  lds
  buffer_load_dwordx4 v56, s[16:19], s67 offen offset:1024  lds
  buffer_load_dwordx4 v56, s[16:19], s67 offen offset:2048  lds
  s_add_u32 m0, s100, 86912
  s_mov_b32 s67, s66
  s_add_u32 s66, s66, s73
  buffer_load_dwordx4 v56, s[12:15], s66 offen offset:0  lds
  buffer_load_dwordx4 v56, s[12:15], s66 offen offset:1024  lds
  buffer_load_dwordx4 v56, s[12:15], s66 offen offset:2048  lds
  s_add_u32 m0, s100, 0
  s_nop 0
  buffer_load_dwordx4 v56, s[16:19], s67 offen offset:0  lds
  buffer_load_dwordx4 v56, s[16:19], s67 offen offset:1024  lds
  buffer_load_dwordx4 v56, s[16:19], s67 offen offset:2048  lds
  s_waitcnt vmcnt(18)
  s_waitcnt lgkmcnt(0)
  s_barrier
  buffer_load_dwordx2 v[16:17], v6, s[4:7], 0 offen offset:60
  v_add_u32 v6, 49152, v6
  v_lshrrev_b32 v4, 16, v34
  v_mad_u32_u24 v4, v4, s78, v3
  buffer_load_dwordx4 v[116:119], v4, s[20:23], 0 offen offset:0
  buffer_load_dwordx4 v[124:127], v4, s[20:23], 0 offen offset:128
  buffer_load_dwordx4 v[132:135], v4, s[20:23], 0 offen offset:256
  s_waitcnt vmcnt(10)
  s_waitcnt lgkmcnt(0)
  s_barrier
  ds_read_b128 v[20:23], v2 offset:54560
  ds_read_b128 v[24:27], v2 offset:54688
  ds_read_b128 v[28:31], v2 offset:54816
  s_waitcnt lgkmcnt(0)
  s_setprio 3
  v_mfma_f32_4x4x4_16b_bf16 v[8:11], v[20:21], v[88:89], 0
  v_mfma_f32_4x4x4_16b_bf16 v[48:51], v[20:21], v[92:93], 0
  v_mfma_f32_4x4x4_16b_bf16 v[12:15], v[22:23], v[90:91], 0
  v_mfma_f32_4x4x4_16b_bf16 v[52:55], v[22:23], v[94:95], 0
  v_mfma_f32_4x4x4_16b_bf16 v[8:11], v[24:25], v[96:97], v[8:11]
  v_mfma_f32_4x4x4_16b_bf16 v[48:51], v[24:25], v[100:101], v[48:51]
  v_mfma_f32_4x4x4_16b_bf16 v[12:15], v[26:27], v[98:99], v[12:15]
  v_mfma_f32_4x4x4_16b_bf16 v[52:55], v[26:27], v[102:103], v[52:55]
  v_mfma_f32_4x4x4_16b_bf16 v[8:11], v[28:29], v[104:105], v[8:11]
  v_mfma_f32_4x4x4_16b_bf16 v[48:51], v[28:29], v[108:109], v[48:51]
  v_mfma_f32_4x4x4_16b_bf16 v[12:15], v[30:31], v[106:107], v[12:15]
  v_mfma_f32_4x4x4_16b_bf16 v[52:55], v[30:31], v[110:111], v[52:55]
  s_setprio 0
  s_add_u32 m0, s100, 99328
  s_mov_b32 s67, s66
  s_add_u32 s66, s66, s73
  buffer_load_dwordx4 v56, s[12:15], s66 offen offset:0  lds
  buffer_load_dwordx4 v56, s[12:15], s66 offen offset:1024  lds
  buffer_load_dwordx4 v56, s[12:15], s66 offen offset:2048  lds
  s_nop 1
  s_add_u32 m0, s100, 12416
  s_nop 0
  buffer_load_dwordx4 v56, s[16:19], s67 offen offset:0  lds
  v_mov_b32_dpp v88, v8 quad_perm:[0,0,0,0] row_mask:0xf bank_mask:0xf
  v_mov_b32_dpp v89, v48 quad_perm:[0,0,0,0] row_mask:0xf bank_mask:0xf
  buffer_load_dwordx4 v56, s[16:19], s67 offen offset:1024  lds
  v_add_f32_dpp v88, v9, v88 quad_perm:[1,1,1,1] row_mask:0xf bank_mask:0xf
  v_add_f32_dpp v89, v49, v89 quad_perm:[1,1,1,1] row_mask:0xf bank_mask:0xf
  buffer_load_dwordx4 v56, s[16:19], s67 offen offset:2048  lds
  v_add_f32_dpp v88, v10, v88 quad_perm:[2,2,2,2] row_mask:0xf bank_mask:0xf
  v_add_f32_dpp v89, v50, v89 quad_perm:[2,2,2,2] row_mask:0xf bank_mask:0xf
  s_add_u32 m0, s100, 62080
  s_mov_b32 s67, s66
  s_add_u32 s66, s66, s73
  buffer_load_dwordx4 v56, s[12:15], s66 offen offset:0  lds
  v_add_f32_dpp v88, v11, v88 quad_perm:[3,3,3,3] row_mask:0xf bank_mask:0xf
  buffer_load_dwordx4 v56, s[12:15], s66 offen offset:1024  lds
  v_add_f32_dpp v89, v51, v89 quad_perm:[3,3,3,3] row_mask:0xf bank_mask:0xf
  v_add_f32_dpp v88, v12, v88 quad_perm:[0,0,0,0] row_mask:0xf bank_mask:0xf
  buffer_load_dwordx4 v56, s[12:15], s66 offen offset:2048  lds
  v_add_f32_dpp v89, v52, v89 quad_perm:[0,0,0,0] row_mask:0xf bank_mask:0xf
  v_add_f32_dpp v88, v13, v88 quad_perm:[1,1,1,1] row_mask:0xf bank_mask:0xf
  s_add_u32 m0, s100, 24832
  s_nop 0
  buffer_load_dwordx4 v56, s[16:19], s67 offen offset:0  lds
  v_add_f32_dpp v89, v53, v89 quad_perm:[1,1,1,1] row_mask:0xf bank_mask:0xf
  v_add_f32_dpp v88, v14, v88 quad_perm:[2,2,2,2] row_mask:0xf bank_mask:0xf
  buffer_load_dwordx4 v56, s[16:19], s67 offen offset:1024  lds
  v_add_f32_dpp v89, v54, v89 quad_perm:[2,2,2,2] row_mask:0xf bank_mask:0xf
  v_add_f32_dpp v88, v15, v88 quad_perm:[3,3,3,3] row_mask:0xf bank_mask:0xf
  buffer_load_dwordx4 v56, s[16:19], s67 offen offset:2048  lds
  v_add_f32_dpp v89, v55, v89 quad_perm:[3,3,3,3] row_mask:0xf bank_mask:0xf
  s_waitcnt vmcnt(16)
  s_waitcnt lgkmcnt(0)
  s_barrier
  v_and_b32 v4, 0xffff, v35
  v_mad_u32_u24 v4, v4, s78, v3
  buffer_load_dwordx4 v[136:139], v4, s[20:23], 0 offen offset:0
  v_add_f32_dpp v88, v88, v88 row_half_mirror row_mask:0xf bank_mask:0xf
  v_add_f32_dpp v89, v89, v89 row_half_mirror row_mask:0xf bank_mask:0xf
  v_max_f32 v90, v88, v89
  buffer_load_dwordx4 v[144:147], v4, s[20:23], 0 offen offset:128
  v_sub_f32 v88, v88, v90
  v_sub_f32 v89, v89, v90
  v_exp_f32 v88, v88
  buffer_load_dwordx4 v[152:155], v4, s[20:23], 0 offen offset:256
  v_exp_f32 v89, v89
  v_lshrrev_b32 v4, 16, v35
  v_mad_u32_u24 v4, v4, s78, v3
  buffer_load_dwordx4 v[140:143], v4, s[20:23], 0 offen offset:0
  s_nop 0
  v_add_f32 v90, v88, v89
  v_rcp_f32 v90, v90
  buffer_load_dwordx4 v[148:151], v4, s[20:23], 0 offen offset:128
  s_nop 0
  v_mul_f32 v90, s56, v90
  v_mul_f32 v88, v88, v90
  buffer_load_dwordx4 v[156:159], v4, s[20:23], 0 offen offset:256
  v_mul_f32 v89, v89, v90
  v_cvt_pk_bf16_f32 v41, v88, v89
  s_waitcnt vmcnt(12)
  s_waitcnt lgkmcnt(0)
  s_barrier
  ds_read_b128 v[20:23], v2 offset:57664
  ds_read_b128 v[24:27], v2 offset:57792
  ds_read_b128 v[28:31], v2 offset:57920
  s_waitcnt lgkmcnt(0)
  s_setprio 3
  v_mfma_f32_4x4x4_16b_bf16 v[8:11], v[20:21], v[112:113], 0
  v_mfma_f32_4x4x4_16b_bf16 v[48:51], v[20:21], v[116:117], 0
  v_mfma_f32_4x4x4_16b_bf16 v[12:15], v[22:23], v[114:115], 0
  v_mfma_f32_4x4x4_16b_bf16 v[52:55], v[22:23], v[118:119], 0
  v_mfma_f32_4x4x4_16b_bf16 v[8:11], v[24:25], v[120:121], v[8:11]
  v_mfma_f32_4x4x4_16b_bf16 v[48:51], v[24:25], v[124:125], v[48:51]
  v_mfma_f32_4x4x4_16b_bf16 v[12:15], v[26:27], v[122:123], v[12:15]
  v_mfma_f32_4x4x4_16b_bf16 v[52:55], v[26:27], v[126:127], v[52:55]
  v_mfma_f32_4x4x4_16b_bf16 v[8:11], v[28:29], v[128:129], v[8:11]
  v_mfma_f32_4x4x4_16b_bf16 v[48:51], v[28:29], v[132:133], v[48:51]
  v_mfma_f32_4x4x4_16b_bf16 v[12:15], v[30:31], v[130:131], v[12:15]
  v_mfma_f32_4x4x4_16b_bf16 v[52:55], v[30:31], v[134:135], v[52:55]
  s_setprio 0
  s_add_u32 m0, s100, 74496
  s_mov_b32 s67, s66
  s_add_u32 s66, s66, s73
  buffer_load_dwordx4 v56, s[12:15], s66 offen offset:0  lds
  buffer_load_dwordx4 v56, s[12:15], s66 offen offset:1024  lds
  buffer_load_dwordx4 v56, s[12:15], s66 offen offset:2048  lds
  s_nop 1
  s_add_u32 m0, s100, 37248
  s_nop 0
  buffer_load_dwordx4 v56, s[16:19], s67 offen offset:0  lds
  v_mov_b32_dpp v112, v8 quad_perm:[0,0,0,0] row_mask:0xf bank_mask:0xf
  v_mov_b32_dpp v113, v48 quad_perm:[0,0,0,0] row_mask:0xf bank_mask:0xf
  buffer_load_dwordx4 v56, s[16:19], s67 offen offset:1024  lds
  v_add_f32_dpp v112, v9, v112 quad_perm:[1,1,1,1] row_mask:0xf bank_mask:0xf
  v_add_f32_dpp v113, v49, v113 quad_perm:[1,1,1,1] row_mask:0xf bank_mask:0xf
  buffer_load_dwordx4 v56, s[16:19], s67 offen offset:2048  lds
  v_add_f32_dpp v112, v10, v112 quad_perm:[2,2,2,2] row_mask:0xf bank_mask:0xf
  v_add_f32_dpp v113, v50, v113 quad_perm:[2,2,2,2] row_mask:0xf bank_mask:0xf
  s_add_u32 m0, s100, 86912
  s_mov_b32 s67, s66
  s_add_u32 s66, s66, s73
  buffer_load_dwordx4 v56, s[12:15], s66 offen offset:0  lds
  v_add_f32_dpp v112, v11, v112 quad_perm:[3,3,3,3] row_mask:0xf bank_mask:0xf
  buffer_load_dwordx4 v56, s[12:15], s66 offen offset:1024  lds
  v_add_f32_dpp v113, v51, v113 quad_perm:[3,3,3,3] row_mask:0xf bank_mask:0xf
  v_add_f32_dpp v112, v12, v112 quad_perm:[0,0,0,0] row_mask:0xf bank_mask:0xf
  buffer_load_dwordx4 v56, s[12:15], s66 offen offset:2048  lds
  v_add_f32_dpp v113, v52, v113 quad_perm:[0,0,0,0] row_mask:0xf bank_mask:0xf
  v_add_f32_dpp v112, v13, v112 quad_perm:[1,1,1,1] row_mask:0xf bank_mask:0xf
  s_add_u32 m0, s100, 49664
  s_nop 0
  buffer_load_dwordx4 v56, s[16:19], s67 offen offset:0  lds
  v_add_f32_dpp v113, v53, v113 quad_perm:[1,1,1,1] row_mask:0xf bank_mask:0xf
  v_add_f32_dpp v112, v14, v112 quad_perm:[2,2,2,2] row_mask:0xf bank_mask:0xf
  buffer_load_dwordx4 v56, s[16:19], s67 offen offset:1024  lds
  v_add_f32_dpp v113, v54, v113 quad_perm:[2,2,2,2] row_mask:0xf bank_mask:0xf
  v_add_f32_dpp v112, v15, v112 quad_perm:[3,3,3,3] row_mask:0xf bank_mask:0xf
  buffer_load_dwordx4 v56, s[16:19], s67 offen offset:2048  lds
  v_add_f32_dpp v113, v55, v113 quad_perm:[3,3,3,3] row_mask:0xf bank_mask:0xf
  s_waitcnt vmcnt(18)
  s_waitcnt lgkmcnt(0)
  s_barrier
  buffer_load_dwordx2 v[16:17], v6, s[4:7], 0 offen offset:60
  v_add_u32 v6, 49152, v6
  v_add_f32_dpp v112, v112, v112 row_half_mirror row_mask:0xf bank_mask:0xf
  v_add_f32_dpp v113, v113, v113 row_half_mirror row_mask:0xf bank_mask:0xf
  v_max_f32 v114, v112, v113
  v_sub_f32 v112, v112, v114
  v_sub_f32 v113, v113, v114
  s_add_u32 m0, s96, 0
  s_add_u32 s64, s69, 0
  buffer_load_dwordx4 v56, s[8:11], s64 offen offset:0 nt lds
  v_exp_f32 v112, v112
  v_exp_f32 v113, v113
  buffer_load_dwordx4 v56, s[8:11], s64 offen offset:1024 nt lds
  s_nop 0
  v_add_f32 v114, v112, v113
  v_rcp_f32 v114, v114
  s_nop 0
  buffer_load_dwordx4 v56, s[8:11], s64 offen offset:2048 nt lds
  v_mul_f32 v114, s56, v114
  v_mul_f32 v112, v112, v114
  v_mul_f32 v113, v113, v114
  v_cvt_pk_bf16_f32 v42, v112, v113
  s_waitcnt vmcnt(10)
  s_waitcnt lgkmcnt(0)
  s_barrier
  ds_read_b128 v[20:23], v2 offset:60768
  ds_read_b128 v[24:27], v2 offset:60896
  ds_read_b128 v[28:31], v2 offset:61024
  s_waitcnt lgkmcnt(0)
  s_setprio 3
  v_mfma_f32_4x4x4_16b_bf16 v[8:11], v[20:21], v[136:137], 0
  v_mfma_f32_4x4x4_16b_bf16 v[48:51], v[20:21], v[140:141], 0
  v_mfma_f32_4x4x4_16b_bf16 v[12:15], v[22:23], v[138:139], 0
  v_mfma_f32_4x4x4_16b_bf16 v[52:55], v[22:23], v[142:143], 0
  v_mfma_f32_4x4x4_16b_bf16 v[8:11], v[24:25], v[144:145], v[8:11]
  v_mfma_f32_4x4x4_16b_bf16 v[48:51], v[24:25], v[148:149], v[48:51]
  v_mfma_f32_4x4x4_16b_bf16 v[12:15], v[26:27], v[146:147], v[12:15]
  v_mfma_f32_4x4x4_16b_bf16 v[52:55], v[26:27], v[150:151], v[52:55]
  v_mfma_f32_4x4x4_16b_bf16 v[8:11], v[28:29], v[152:153], v[8:11]
  v_mfma_f32_4x4x4_16b_bf16 v[48:51], v[28:29], v[156:157], v[48:51]
  v_mfma_f32_4x4x4_16b_bf16 v[12:15], v[30:31], v[154:155], v[12:15]
  v_mfma_f32_4x4x4_16b_bf16 v[52:55], v[30:31], v[158:159], v[52:55]
  s_setprio 0
  s_add_u32 m0, s100, 99328
  s_mov_b32 s67, s66
  s_add_u32 s66, s66, s73
  buffer_load_dwordx4 v56, s[12:15], s66 offen offset:0  lds
  buffer_load_dwordx4 v56, s[12:15], s66 offen offset:1024  lds
  s_nop 1
  buffer_load_dwordx4 v56, s[12:15], s66 offen offset:2048  lds
  v_mov_b32_dpp v136, v8 quad_perm:[0,0,0,0] row_mask:0xf bank_mask:0xf
  v_mov_b32_dpp v137, v48 quad_perm:[0,0,0,0] row_mask:0xf bank_mask:0xf
  v_add_f32_dpp v136, v9, v136 quad_perm:[1,1,1,1] row_mask:0xf bank_mask:0xf
  s_add_u32 m0, s100, 0
  s_nop 0
  buffer_load_dwordx4 v56, s[16:19], s67 offen offset:0  lds
  v_add_f32_dpp v137, v49, v137 quad_perm:[1,1,1,1] row_mask:0xf bank_mask:0xf
  v_add_f32_dpp v136, v10, v136 quad_perm:[2,2,2,2] row_mask:0xf bank_mask:0xf
  v_add_f32_dpp v137, v50, v137 quad_perm:[2,2,2,2] row_mask:0xf bank_mask:0xf
  buffer_load_dwordx4 v56, s[16:19], s67 offen offset:1024  lds
  v_add_f32_dpp v136, v11, v136 quad_perm:[3,3,3,3] row_mask:0xf bank_mask:0xf
  v_add_f32_dpp v137, v51, v137 quad_perm:[3,3,3,3] row_mask:0xf bank_mask:0xf
  buffer_load_dwordx4 v56, s[16:19], s67 offen offset:2048  lds
  v_add_f32_dpp v136, v12, v136 quad_perm:[0,0,0,0] row_mask:0xf bank_mask:0xf
  v_add_f32_dpp v137, v52, v137 quad_perm:[0,0,0,0] row_mask:0xf bank_mask:0xf
  v_add_f32_dpp v136, v13, v136 quad_perm:[1,1,1,1] row_mask:0xf bank_mask:0xf
  s_add_u32 m0, s100, 62080
  s_mov_b32 s67, s66
  s_add_u32 s66, s66, s73
  buffer_load_dwordx4 v56, s[12:15], s66 offen offset:0  lds
  v_add_f32_dpp v137, v53, v137 quad_perm:[1,1,1,1] row_mask:0xf bank_mask:0xf
  v_add_f32_dpp v136, v14, v136 quad_perm:[2,2,2,2] row_mask:0xf bank_mask:0xf
  v_add_f32_dpp v137, v54, v137 quad_perm:[2,2,2,2] row_mask:0xf bank_mask:0xf
  buffer_load_dwordx4 v56, s[12:15], s66 offen offset:1024  lds
  v_add_f32_dpp v136, v15, v136 quad_perm:[3,3,3,3] row_mask:0xf bank_mask:0xf
  v_add_f32_dpp v137, v55, v137 quad_perm:[3,3,3,3] row_mask:0xf bank_mask:0xf
  s_waitcnt vmcnt(12)
  s_waitcnt lgkmcnt(0)
  s_barrier
  buffer_load_dwordx4 v56, s[12:15], s66 offen offset:2048  lds
  v_add_f32_dpp v136, v136, v136 row_half_mirror row_mask:0xf bank_mask:0xf
  v_add_f32_dpp v137, v137, v137 row_half_mirror row_mask:0xf bank_mask:0xf
  v_max_f32 v138, v136, v137
  s_add_u32 m0, s100, 12416
  s_nop 0
  buffer_load_dwordx4 v56, s[16:19], s67 offen offset:0  lds
  v_sub_f32 v136, v136, v138
  v_sub_f32 v137, v137, v138
  buffer_load_dwordx4 v56, s[16:19], s67 offen offset:1024  lds
  v_exp_f32 v136, v136
  buffer_load_dwordx4 v56, s[16:19], s67 offen offset:2048  lds
  v_exp_f32 v137, v137
  s_add_u32 m0, s100, 74496
  s_mov_b32 s67, s66
  s_add_u32 s66, s66, s73
  buffer_load_dwordx4 v56, s[12:15], s66 offen offset:0  lds
  s_nop 0
  v_add_f32 v138, v136, v137
  v_rcp_f32 v138, v138
  buffer_load_dwordx4 v56, s[12:15], s66 offen offset:1024  lds
  s_nop 0
  buffer_load_dwordx4 v56, s[12:15], s66 offen offset:2048  lds
  v_mul_f32 v138, s56, v138
  v_mul_f32 v136, v136, v138
  s_add_u32 m0, s100, 24832
  s_nop 0
  buffer_load_dwordx4 v56, s[16:19], s67 offen offset:0  lds
  v_mul_f32 v137, v137, v138
  v_cvt_pk_bf16_f32 v43, v136, v137
  s_waitcnt vmcnt(10)
  s_waitcnt lgkmcnt(0)
  s_barrier
  buffer_load_dwordx4 v56, s[16:19], s67 offen offset:1024  lds
  buffer_load_dwordx4 v56, s[16:19], s67 offen offset:2048  lds
  s_add_u32 m0, s100, 86912
  s_mov_b32 s67, s66
  s_add_u32 s66, s66, s73
  buffer_load_dwordx4 v56, s[12:15], s66 offen offset:0  lds
  buffer_load_dwordx4 v56, s[12:15], s66 offen offset:1024  lds
  buffer_load_dwordx4 v56, s[12:15], s66 offen offset:2048  lds
  s_add_u32 m0, s100, 37248
  s_nop 0
  buffer_load_dwordx4 v56, s[16:19], s67 offen offset:0  lds
  buffer_load_dwordx4 v56, s[16:19], s67 offen offset:1024  lds
  buffer_load_dwordx4 v56, s[16:19], s67 offen offset:2048  lds
  s_waitcnt vmcnt(12)
  s_waitcnt lgkmcnt(0)
  s_barrier
  buffer_load_dwordx2 v[16:17], v6, s[4:7], 0 offen offset:60
  v_add_u32 v6, 49152, v6
  s_add_u32 m0, s96, 3104
  s_add_u32 s64, s69, 3072
  buffer_load_dwordx4 v56, s[8:11], s64 offen offset:0 nt lds
  buffer_load_dwordx4 v56, s[8:11], s64 offen offset:1024 nt lds
  buffer_load_dwordx4 v56, s[8:11], s64 offen offset:2048 nt lds
  s_waitcnt vmcnt(10)
  s_waitcnt lgkmcnt(0)
  s_barrier
  s_add_u32 m0, s100, 99328
  s_mov_b32 s67, s66
  s_add_u32 s66, s66, s73
  buffer_load_dwordx4 v56, s[12:15], s66 offen offset:0  lds
  buffer_load_dwordx4 v56, s[12:15], s66 offen offset:1024  lds
  buffer_load_dwordx4 v56, s[12:15], s66 offen offset:2048  lds
  s_add_u32 m0, s100, 49664
  s_nop 0
  buffer_load_dwordx4 v56, s[16:19], s67 offen offset:0  lds
  buffer_load_dwordx4 v56, s[16:19], s67 offen offset:1024  lds
  buffer_load_dwordx4 v56, s[16:19], s67 offen offset:2048  lds
  s_add_u32 m0, s100, 62080
  s_mov_b32 s67, s66
  s_add_u32 s66, s66, s73
  buffer_load_dwordx4 v56, s[12:15], s66 offen offset:0  lds
  buffer_load_dwordx4 v56, s[12:15], s66 offen offset:1024  lds
  s_waitcnt vmcnt(12)
  s_waitcnt lgkmcnt(0)
  s_barrier
  buffer_load_dwordx4 v56, s[12:15], s66 offen offset:2048  lds
  s_add_u32 m0, s100, 0
  s_nop 0
  buffer_load_dwordx4 v56, s[16:19], s67 offen offset:0  lds
  buffer_load_dwordx4 v56, s[16:19], s67 offen offset:1024  lds
  buffer_load_dwordx4 v56, s[16:19], s67 offen offset:2048  lds
  s_add_u32 m0, s100, 74496
  s_mov_b32 s67, s66
  s_add_u32 s66, s66, s73
  buffer_load_dwordx4 v56, s[12:15], s66 offen offset:0  lds
  buffer_load_dwordx4 v56, s[12:15], s66 offen offset:1024  lds
  buffer_load_dwordx4 v56, s[12:15], s66 offen offset:2048  lds
  s_add_u32 m0, s100, 12416
  s_nop 0
  buffer_load_dwordx4 v56, s[16:19], s67 offen offset:0  lds
  s_waitcnt vmcnt(10)
  s_waitcnt lgkmcnt(0)
  s_barrier
  buffer_load_dwordx4 v56, s[16:19], s67 offen offset:1024  lds
  buffer_load_dwordx4 v56, s[16:19], s67 offen offset:2048  lds
  s_add_u32 m0, s100, 86912
  s_mov_b32 s67, s66
  s_add_u32 s66, s66, s73
  buffer_load_dwordx4 v56, s[12:15], s66 offen offset:0  lds
  buffer_load_dwordx4 v56, s[12:15], s66 offen offset:1024  lds
  buffer_load_dwordx4 v56, s[12:15], s66 offen offset:2048  lds
  s_add_u32 m0, s100, 24832
  s_nop 0
  buffer_load_dwordx4 v56, s[16:19], s67 offen offset:0  lds
  buffer_load_dwordx4 v56, s[16:19], s67 offen offset:1024  lds
  buffer_load_dwordx4 v56, s[16:19], s67 offen offset:2048  lds
  s_waitcnt vmcnt(12)
  s_waitcnt lgkmcnt(0)
  s_barrier
  buffer_load_dwordx2 v[16:17], v6, s[4:7], 0 offen offset:60
  v_add_u32 v6, 49152, v6
  s_add_u32 m0, s96, 6208
  s_add_u32 s64, s69, 6144
  buffer_load_dwordx4 v56, s[8:11], s64 offen offset:0 nt lds
  buffer_load_dwordx4 v56, s[8:11], s64 offen offset:1024 nt lds
  buffer_load_dwordx4 v56, s[8:11], s64 offen offset:2048 nt lds
  s_waitcnt vmcnt(10)
  s_waitcnt lgkmcnt(0)
  s_barrier
  s_add_u32 m0, s100, 99328
  s_mov_b32 s67, s66
  s_add_u32 s66, s66, s73
  buffer_load_dwordx4 v56, s[12:15], s66 offen offset:0  lds
  buffer_load_dwordx4 v56, s[12:15], s66 offen offset:1024  lds
  buffer_load_dwordx4 v56, s[12:15], s66 offen offset:2048  lds
  s_add_u32 m0, s100, 37248
  s_nop 0
  buffer_load_dwordx4 v56, s[16:19], s67 offen offset:0  lds
  buffer_load_dwordx4 v56, s[16:19], s67 offen offset:1024  lds
  buffer_load_dwordx4 v56, s[16:19], s67 offen offset:2048  lds
  s_add_u32 m0, s100, 62080
  s_mov_b32 s67, s66
  s_add_u32 s66, s66, s73
  buffer_load_dwordx4 v56, s[12:15], s66 offen offset:0  lds
  buffer_load_dwordx4 v56, s[12:15], s66 offen offset:1024  lds
  s_waitcnt vmcnt(12)
  s_waitcnt lgkmcnt(0)
  s_barrier
  buffer_load_dwordx4 v56, s[12:15], s66 offen offset:2048  lds
  s_add_u32 m0, s100, 49664
  s_nop 0
  buffer_load_dwordx4 v56, s[16:19], s67 offen offset:0  lds
  buffer_load_dwordx4 v56, s[16:19], s67 offen offset:1024  lds
  buffer_load_dwordx4 v56, s[16:19], s67 offen offset:2048  lds
  s_add_u32 m0, s100, 74496
  s_mov_b32 s67, s66
  s_add_u32 s66, s66, s73
  buffer_load_dwordx4 v56, s[12:15], s66 offen offset:0  lds
  buffer_load_dwordx4 v56, s[12:15], s66 offen offset:1024  lds
  buffer_load_dwordx4 v56, s[12:15], s66 offen offset:2048  lds
  s_add_u32 m0, s100, 0
  s_nop 0
  buffer_load_dwordx4 v56, s[16:19], s67 offen offset:0  lds
  s_waitcnt vmcnt(10)
  s_waitcnt lgkmcnt(0)
  s_barrier
  buffer_load_dwordx4 v56, s[16:19], s67 offen offset:1024  lds
  buffer_load_dwordx4 v56, s[16:19], s67 offen offset:2048  lds
  s_add_u32 m0, s100, 86912
  s_mov_b32 s67, s66
  s_add_u32 s66, s66, s73
  buffer_load_dwordx4 v56, s[12:15], s66 offen offset:0  lds
  buffer_load_dwordx4 v56, s[12:15], s66 offen offset:1024  lds
  buffer_load_dwordx4 v56, s[12:15], s66 offen offset:2048  lds
  s_add_u32 m0, s100, 12416
  s_nop 0
  buffer_load_dwordx4 v56, s[16:19], s67 offen offset:0  lds
  buffer_load_dwordx4 v56, s[16:19], s67 offen offset:1024  lds
  buffer_load_dwordx4 v56, s[16:19], s67 offen offset:2048  lds
  s_waitcnt vmcnt(12)
  s_waitcnt lgkmcnt(0)
  s_barrier
  buffer_load_dwordx2 v[16:17], v6, s[4:7], 0 offen offset:60
  v_add_u32 v6, 49152, v6
  s_add_u32 m0, s96, 9312
  s_add_u32 s64, s69, 9216
  buffer_load_dwordx4 v56, s[8:11], s64 offen offset:0 nt lds
  buffer_load_dwordx4 v56, s[8:11], s64 offen offset:1024 nt lds
  buffer_load_dwordx4 v56, s[8:11], s64 offen offset:2048 nt lds
  s_waitcnt vmcnt(10)
  s_waitcnt lgkmcnt(0)
  s_barrier
  s_add_u32 m0, s100, 99328
  s_mov_b32 s67, s66
  s_add_u32 s66, s66, s73
  buffer_load_dwordx4 v56, s[12:15], s66 offen offset:0  lds
  buffer_load_dwordx4 v56, s[12:15], s66 offen offset:1024  lds
  buffer_load_dwordx4 v56, s[12:15], s66 offen offset:2048  lds
  s_add_u32 m0, s100, 24832
  s_nop 0
  buffer_load_dwordx4 v56, s[16:19], s67 offen offset:0  lds
  buffer_load_dwordx4 v56, s[16:19], s67 offen offset:1024  lds
  buffer_load_dwordx4 v56, s[16:19], s67 offen offset:2048  lds
  s_add_u32 m0, s100, 62080
  s_mov_b32 s67, s66
  s_add_u32 s66, s66, s73
  buffer_load_dwordx4 v56, s[12:15], s66 offen offset:0  lds
  buffer_load_dwordx4 v56, s[12:15], s66 offen offset:1024  lds
  buffer_load_dwordx4 v56, s[12:15], s66 offen offset:2048  lds
  s_add_u32 m0, s100, 37248
  s_nop 0
  buffer_load_dwordx4 v56, s[16:19], s67 offen offset:0  lds
  buffer_load_dwordx4 v56, s[16:19], s67 offen offset:1024  lds
  buffer_load_dwordx4 v56, s[16:19], s67 offen offset:2048  lds
  s_waitcnt vmcnt(16)
  s_waitcnt lgkmcnt(0)
  s_barrier
  v_and_b32 v4, 0xffff, v36
  v_mad_u32_u24 v4, v4, s78, v3
  buffer_load_dwordx4 v[160:163], v4, s[20:23], 0 offen offset:0
  buffer_load_dwordx4 v[168:171], v4, s[20:23], 0 offen offset:128
  buffer_load_dwordx4 v[176:179], v4, s[20:23], 0 offen offset:256
  v_lshrrev_b32 v4, 16, v36
  v_mad_u32_u24 v4, v4, s78, v3
  buffer_load_dwordx4 v[164:167], v4, s[20:23], 0 offen offset:0
  buffer_load_dwordx4 v[172:175], v4, s[20:23], 0 offen offset:128
  buffer_load_dwordx4 v[180:183], v4, s[20:23], 0 offen offset:256
  s_waitcnt vmcnt(12)
  s_waitcnt lgkmcnt(0)
  s_barrier
  s_add_u32 m0, s100, 74496
  s_mov_b32 s67, s66
  s_add_u32 s66, s66, s73
  buffer_load_dwordx4 v56, s[12:15], s66 offen offset:0  lds
  buffer_load_dwordx4 v56, s[12:15], s66 offen offset:1024  lds
  buffer_load_dwordx4 v56, s[12:15], s66 offen offset:2048  lds
  s_add_u32 m0, s100, 49664
  s_nop 0
  buffer_load_dwordx4 v56, s[16:19], s67 offen offset:0  lds
  buffer_load_dwordx4 v56, s[16:19], s67 offen offset:1024  lds
  buffer_load_dwordx4 v56, s[16:19], s67 offen offset:2048  lds
  s_add_u32 m0, s100, 86912
  s_mov_b32 s67, s66
  s_add_u32 s66, s66, s73
  buffer_load_dwordx4 v56, s[12:15], s66 offen offset:0  lds
  buffer_load_dwordx4 v56, s[12:15], s66 offen offset:1024  lds
  buffer_load_dwordx4 v56, s[12:15], s66 offen offset:2048  lds
  s_add_u32 m0, s100, 0
  s_nop 0
  buffer_load_dwordx4 v56, s[16:19], s67 offen offset:0  lds
  buffer_load_dwordx4 v56, s[16:19], s67 offen offset:1024  lds
  buffer_load_dwordx4 v56, s[16:19], s67 offen offset:2048  lds
  s_waitcnt vmcnt(18)
  s_waitcnt lgkmcnt(0)
  s_barrier
  buffer_load_dwordx2 v[16:17], v6, s[4:7], 0 offen offset:60
  v_add_u32 v6, 49152, v6
  v_and_b32 v4, 0xffff, v37
  v_mad_u32_u24 v4, v4, s78, v3
  buffer_load_dwordx4 v[184:187], v4, s[20:23], 0 offen offset:0
  buffer_load_dwordx4 v[192:195], v4, s[20:23], 0 offen offset:128
  buffer_load_dwordx4 v[200:203], v4, s[20:23], 0 offen offset:256
  s_waitcnt vmcnt(10)
  s_waitcnt lgkmcnt(0)
  s_barrier
  ds_read_b128 v[20:23], v2 offset:51456
  ds_read_b128 v[24:27], v2 offset:51584
  ds_read_b128 v[28:31], v2 offset:51712
  s_waitcnt lgkmcnt(0)
  s_setprio 3
  v_mfma_f32_4x4x4_16b_bf16 v[8:11], v[20:21], v[160:161], 0
  v_mfma_f32_4x4x4_16b_bf16 v[48:51], v[20:21], v[164:165], 0
  v_mfma_f32_4x4x4_16b_bf16 v[12:15], v[22:23], v[162:163], 0
  v_mfma_f32_4x4x4_16b_bf16 v[52:55], v[22:23], v[166:167], 0
  v_mfma_f32_4x4x4_16b_bf16 v[8:11], v[24:25], v[168:169], v[8:11]
  v_mfma_f32_4x4x4_16b_bf16 v[48:51], v[24:25], v[172:173], v[48:51]
  v_mfma_f32_4x4x4_16b_bf16 v[12:15], v[26:27], v[170:171], v[12:15]
  v_mfma_f32_4x4x4_16b_bf16 v[52:55], v[26:27], v[174:175], v[52:55]
  v_mfma_f32_4x4x4_16b_bf16 v[8:11], v[28:29], v[176:177], v[8:11]
  v_mfma_f32_4x4x4_16b_bf16 v[48:51], v[28:29], v[180:181], v[48:51]
  v_mfma_f32_4x4x4_16b_bf16 v[12:15], v[30:31], v[178:179], v[12:15]
  v_mfma_f32_4x4x4_16b_bf16 v[52:55], v[30:31], v[182:183], v[52:55]
  s_setprio 0
  s_add_u32 m0, s100, 99328
  s_mov_b32 s67, s66
  s_add_u32 s66, s66, s73
  buffer_load_dwordx4 v56, s[12:15], s66 offen offset:0  lds
  buffer_load_dwordx4 v56, s[12:15], s66 offen offset:1024  lds
  buffer_load_dwordx4 v56, s[12:15], s66 offen offset:2048  lds
  s_nop 1
  s_add_u32 m0, s100, 12416
  s_nop 0
  buffer_load_dwordx4 v56, s[16:19], s67 offen offset:0  lds
  v_mov_b32_dpp v160, v8 quad_perm:[0,0,0,0] row_mask:0xf bank_mask:0xf
  v_mov_b32_dpp v161, v48 quad_perm:[0,0,0,0] row_mask:0xf bank_mask:0xf
  buffer_load_dwordx4 v56, s[16:19], s67 offen offset:1024  lds
  v_add_f32_dpp v160, v9, v160 quad_perm:[1,1,1,1] row_mask:0xf bank_mask:0xf
  v_add_f32_dpp v161, v49, v161 quad_perm:[1,1,1,1] row_mask:0xf bank_mask:0xf
  buffer_load_dwordx4 v56, s[16:19], s67 offen offset:2048  lds
  v_add_f32_dpp v160, v10, v160 quad_perm:[2,2,2,2] row_mask:0xf bank_mask:0xf
  v_add_f32_dpp v161, v50, v161 quad_perm:[2,2,2,2] row_mask:0xf bank_mask:0xf
  s_add_u32 m0, s100, 62080
  s_mov_b32 s67, s66
  s_add_u32 s66, s66, s73
  buffer_load_dwordx4 v56, s[12:15], s66 offen offset:0  lds
  v_add_f32_dpp v160, v11, v160 quad_perm:[3,3,3,3] row_mask:0xf bank_mask:0xf
  buffer_load_dwordx4 v56, s[12:15], s66 offen offset:1024  lds
  v_add_f32_dpp v161, v51, v161 quad_perm:[3,3,3,3] row_mask:0xf bank_mask:0xf
  v_add_f32_dpp v160, v12, v160 quad_perm:[0,0,0,0] row_mask:0xf bank_mask:0xf
  buffer_load_dwordx4 v56, s[12:15], s66 offen offset:2048  lds
  v_add_f32_dpp v161, v52, v161 quad_perm:[0,0,0,0] row_mask:0xf bank_mask:0xf
  v_add_f32_dpp v160, v13, v160 quad_perm:[1,1,1,1] row_mask:0xf bank_mask:0xf
  s_add_u32 m0, s100, 24832
  s_nop 0
  buffer_load_dwordx4 v56, s[16:19], s67 offen offset:0  lds
  v_add_f32_dpp v161, v53, v161 quad_perm:[1,1,1,1] row_mask:0xf bank_mask:0xf
  v_add_f32_dpp v160, v14, v160 quad_perm:[2,2,2,2] row_mask:0xf bank_mask:0xf
  buffer_load_dwordx4 v56, s[16:19], s67 offen offset:1024  lds
  v_add_f32_dpp v161, v54, v161 quad_perm:[2,2,2,2] row_mask:0xf bank_mask:0xf
  v_add_f32_dpp v160, v15, v160 quad_perm:[3,3,3,3] row_mask:0xf bank_mask:0xf
  buffer_load_dwordx4 v56, s[16:19], s67 offen offset:2048  lds
  v_add_f32_dpp v161, v55, v161 quad_perm:[3,3,3,3] row_mask:0xf bank_mask:0xf
  s_waitcnt vmcnt(16)
  s_waitcnt lgkmcnt(0)
  s_barrier
  v_and_b32 v4, 0xffff, v38
  v_mad_u32_u24 v4, v4, s78, v3
  buffer_load_dwordx4 v[208:211], v4, s[20:23], 0 offen offset:0
  v_add_f32_dpp v160, v160, v160 row_half_mirror row_mask:0xf bank_mask:0xf
  v_add_f32_dpp v161, v161, v161 row_half_mirror row_mask:0xf bank_mask:0xf
  v_max_f32 v162, v160, v161
  v_sub_f32 v160, v160, v162
  v_sub_f32 v161, v161, v162
  v_mul_f32 v160, s74, v160
  v_mul_f32 v161, s74, v161
  buffer_load_dwordx4 v[216:219], v4, s[20:23], 0 offen offset:128
  v_exp_f32 v160, v160
  v_exp_f32 v161, v161
  s_nop 0
  v_add_f32 v162, v160, v161
  v_rcp_f32 v162, v162
  buffer_load_dwordx4 v[224:227], v4, s[20:23], 0 offen offset:256
  s_nop 0
  v_mul_f32 v162, s56, v162
  v_mul_f32 v160, v160, v162
  v_mul_f32 v161, v161, v162
  v_cvt_pk_bf16_f32 v44, v160, v161
  v_lshrrev_b32 v4, 16, v38
  v_mad_u32_u24 v4, v4, s78, v3
  buffer_load_dwordx4 v[212:215], v4, s[20:23], 0 offen offset:0
  ds_read_b128 v[112:115], v2 offset:57664
  ds_read_b128 v[116:119], v2 offset:57792
  ds_read_b128 v[120:123], v2 offset:57920
  buffer_load_dwordx4 v[220:223], v4, s[20:23], 0 offen offset:128
  ds_read_b128 v[88:91], v2 offset:54560
  ds_read_b128 v[92:95], v2 offset:54688
  ds_read_b128 v[96:99], v2 offset:54816
  buffer_load_dwordx4 v[228:231], v4, s[20:23], 0 offen offset:256
  ds_read_b128 v[136:139], v2 offset:60768
  ds_read_b128 v[140:143], v2 offset:60896
  ds_read_b128 v[144:147], v2 offset:61024
  s_waitcnt vmcnt(12)
  s_waitcnt lgkmcnt(0)
  s_barrier
  s_add_u32 m0, s100, 74496
  s_mov_b32 s67, s66
  s_add_u32 s66, s66, s73
  buffer_load_dwordx4 v56, s[12:15], s66 offen offset:0  lds
  buffer_load_dwordx4 v56, s[12:15], s66 offen offset:1024  lds
  buffer_load_dwordx4 v56, s[12:15], s66 offen offset:2048  lds
  s_add_u32 m0, s100, 37248
  s_nop 0
  buffer_load_dwordx4 v56, s[16:19], s67 offen offset:0  lds
  buffer_load_dwordx4 v56, s[16:19], s67 offen offset:1024  lds
  buffer_load_dwordx4 v56, s[16:19], s67 offen offset:2048  lds
  s_add_u32 m0, s100, 86912
  s_mov_b32 s67, s66
  s_add_u32 s66, s66, s73
  buffer_load_dwordx4 v56, s[12:15], s66 offen offset:0  lds
  buffer_load_dwordx4 v56, s[12:15], s66 offen offset:1024  lds
  buffer_load_dwordx4 v56, s[12:15], s66 offen offset:2048  lds
  s_add_u32 m0, s100, 49664
  s_nop 0
  buffer_load_dwordx4 v56, s[16:19], s67 offen offset:0  lds
  buffer_load_dwordx4 v56, s[16:19], s67 offen offset:1024  lds
  buffer_load_dwordx4 v56, s[16:19], s67 offen offset:2048  lds
  s_waitcnt vmcnt(18)
  s_waitcnt lgkmcnt(0)
  s_barrier
  buffer_load_dwordx2 v[16:17], v6, s[4:7], 0 offen offset:60
  v_add_u32 v6, 49152, v6
  v_sub_u32 v7, v1, v3
  v_mul_u32_u24 v7, 25, v7
  v_lshrrev_b32 v4, 16, v37
  v_mad_u32_u24 v4, v4, s78, v3
  buffer_load_dwordx4 v[188:191], v4, s[20:23], 0 offen offset:0
  s_mov_b32 s62, 0xaaab
  v_lshrrev_b32 v7, 3, v7
  v_mul_u32_u24 v7, s62, v7
  buffer_load_dwordx4 v[196:199], v4, s[20:23], 0 offen offset:128
  s_sub_u32 s62, s96, 51456
  v_lshrrev_b32 v7, 17, v7
  buffer_load_dwordx4 v[204:207], v4, s[20:23], 0 offen offset:256
  v_add_u32 v7, s62, v7
  v_add_u32 v2, v7, v3
  s_waitcnt vmcnt(10)
  s_waitcnt lgkmcnt(0)
  s_barrier
  s_waitcnt lgkmcnt(0)
  s_setprio 3
  v_mfma_f32_4x4x4_16b_bf16 v[8:11], v[112:113], v[208:209], 0
  v_mfma_f32_4x4x4_16b_bf16 v[48:51], v[112:113], v[212:213], 0
  v_mfma_f32_4x4x4_16b_bf16 v[12:15], v[114:115], v[210:211], 0
  v_mfma_f32_4x4x4_16b_bf16 v[52:55], v[114:115], v[214:215], 0
  v_mfma_f32_4x4x4_16b_bf16 v[8:11], v[116:117], v[216:217], v[8:11]
  v_mfma_f32_4x4x4_16b_bf16 v[48:51], v[116:117], v[220:221], v[48:51]
  v_mfma_f32_4x4x4_16b_bf16 v[12:15], v[118:119], v[218:219], v[12:15]
  v_mfma_f32_4x4x4_16b_bf16 v[52:55], v[118:119], v[222:223], v[52:55]
  v_mfma_f32_4x4x4_16b_bf16 v[8:11], v[120:121], v[224:225], v[8:11]
  v_mfma_f32_4x4x4_16b_bf16 v[48:51], v[120:121], v[228:229], v[48:51]
  v_mfma_f32_4x4x4_16b_bf16 v[12:15], v[122:123], v[226:227], v[12:15]
  v_mfma_f32_4x4x4_16b_bf16 v[52:55], v[122:123], v[230:231], v[52:55]
  s_setprio 0
  s_add_u32 m0, s100, 99328
  s_mov_b32 s67, s66
  s_add_u32 s66, s66, s73
  s_cmp_eq_u32 s54, 32
  s_cselect_b32 s66, s95, s66
  s_cselect_b32 s73, 0xffffd000, s73
  buffer_load_dwordx4 v56, s[12:15], s66 offen offset:0  lds
  s_nop 1
  v_mov_b32_dpp v208, v8 quad_perm:[0,0,0,0] row_mask:0xf bank_mask:0xf
  buffer_load_dwordx4 v56, s[12:15], s66 offen offset:1024  lds
  v_mov_b32_dpp v209, v48 quad_perm:[0,0,0,0] row_mask:0xf bank_mask:0xf
  buffer_load_dwordx4 v56, s[12:15], s66 offen offset:2048  lds
  v_add_f32_dpp v208, v9, v208 quad_perm:[1,1,1,1] row_mask:0xf bank_mask:0xf
  v_add_f32_dpp v209, v49, v209 quad_perm:[1,1,1,1] row_mask:0xf bank_mask:0xf
  s_add_u32 m0, s100, 0
  s_nop 0
  buffer_load_dwordx4 v56, s[16:19], s67 offen offset:0  lds
  v_add_f32_dpp v208, v10, v208 quad_perm:[2,2,2,2] row_mask:0xf bank_mask:0xf
  buffer_load_dwordx4 v56, s[16:19], s67 offen offset:1024  lds
  v_add_f32_dpp v209, v50, v209 quad_perm:[2,2,2,2] row_mask:0xf bank_mask:0xf
  buffer_load_dwordx4 v56, s[16:19], s67 offen offset:2048  lds
  v_add_f32_dpp v208, v11, v208 quad_perm:[3,3,3,3] row_mask:0xf bank_mask:0xf
  v_add_f32_dpp v209, v51, v209 quad_perm:[3,3,3,3] row_mask:0xf bank_mask:0xf
  s_add_u32 m0, s100, 62080
  s_mov_b32 s67, s66
  s_add_u32 s66, s66, s73
  buffer_load_dwordx4 v56, s[12:15], s66 offen offset:0  lds
  v_add_f32_dpp v208, v12, v208 quad_perm:[0,0,0,0] row_mask:0xf bank_mask:0xf
  buffer_load_dwordx4 v56, s[12:15], s66 offen offset:1024  lds
  v_add_f32_dpp v209, v52, v209 quad_perm:[0,0,0,0] row_mask:0xf bank_mask:0xf
  v_add_f32_dpp v208, v13, v208 quad_perm:[1,1,1,1] row_mask:0xf bank_mask:0xf
  buffer_load_dwordx4 v56, s[12:15], s66 offen offset:2048  lds
  v_add_f32_dpp v209, v53, v209 quad_perm:[1,1,1,1] row_mask:0xf bank_mask:0xf
  s_add_u32 m0, s100, 12416
  s_nop 0
  buffer_load_dwordx4 v56, s[16:19], s67 offen offset:0  lds
  v_add_f32_dpp v208, v14, v208 quad_perm:[2,2,2,2] row_mask:0xf bank_mask:0xf
  v_add_f32_dpp v209, v54, v209 quad_perm:[2,2,2,2] row_mask:0xf bank_mask:0xf
  buffer_load_dwordx4 v56, s[16:19], s67 offen offset:1024  lds
  v_add_f32_dpp v208, v15, v208 quad_perm:[3,3,3,3] row_mask:0xf bank_mask:0xf
  buffer_load_dwordx4 v56, s[16:19], s67 offen offset:2048  lds
  v_add_f32_dpp v209, v55, v209 quad_perm:[3,3,3,3] row_mask:0xf bank_mask:0xf
  s_waitcnt vmcnt(16)
  s_waitcnt lgkmcnt(0)
  s_barrier
  v_and_b32 v4, 0xffff, v39
  v_mad_u32_u24 v4, v4, s78, v3
  buffer_load_dwordx4 v[232:235], v4, s[20:23], 0 offen offset:0
  v_add_f32_dpp v208, v208, v208 row_half_mirror row_mask:0xf bank_mask:0xf
  v_add_f32_dpp v209, v209, v209 row_half_mirror row_mask:0xf bank_mask:0xf
  v_max_f32 v210, v208, v209
  v_sub_f32 v208, v208, v210
  buffer_load_dwordx4 v[240:243], v4, s[20:23], 0 offen offset:128
  v_sub_f32 v209, v209, v210
  v_mul_f32 v208, s74, v208
  v_mul_f32 v209, s74, v209
  buffer_load_dwordx4 v[248:251], v4, s[20:23], 0 offen offset:256
  v_exp_f32 v208, v208
  v_exp_f32 v209, v209
  v_lshrrev_b32 v4, 16, v39
  v_mad_u32_u24 v4, v4, s78, v3
  buffer_load_dwordx4 v[236:239], v4, s[20:23], 0 offen offset:0
  s_nop 0
  v_add_f32 v210, v208, v209
  v_rcp_f32 v210, v210
  buffer_load_dwordx4 v[244:247], v4, s[20:23], 0 offen offset:128
  s_nop 0
  v_mul_f32 v210, s56, v210
  buffer_load_dwordx4 v[252:255], v4, s[20:23], 0 offen offset:256
  v_mul_f32 v208, v208, v210
  v_mul_f32 v209, v209, v210
  v_cvt_pk_bf16_f32 v46, v208, v209
  s_waitcnt vmcnt(12)
  s_waitcnt lgkmcnt(0)
  s_barrier
  s_waitcnt lgkmcnt(0)
  s_setprio 3
  v_mfma_f32_4x4x4_16b_bf16 v[8:11], v[88:89], v[184:185], 0
  v_mfma_f32_4x4x4_16b_bf16 v[48:51], v[88:89], v[188:189], 0
  v_mfma_f32_4x4x4_16b_bf16 v[12:15], v[90:91], v[186:187], 0
  v_mfma_f32_4x4x4_16b_bf16 v[52:55], v[90:91], v[190:191], 0
  v_mfma_f32_4x4x4_16b_bf16 v[8:11], v[92:93], v[192:193], v[8:11]
  v_mfma_f32_4x4x4_16b_bf16 v[48:51], v[92:93], v[196:197], v[48:51]
  v_mfma_f32_4x4x4_16b_bf16 v[12:15], v[94:95], v[194:195], v[12:15]
  v_mfma_f32_4x4x4_16b_bf16 v[52:55], v[94:95], v[198:199], v[52:55]
  v_mfma_f32_4x4x4_16b_bf16 v[8:11], v[96:97], v[200:201], v[8:11]
  v_mfma_f32_4x4x4_16b_bf16 v[48:51], v[96:97], v[204:205], v[48:51]
  v_mfma_f32_4x4x4_16b_bf16 v[12:15], v[98:99], v[202:203], v[12:15]
  v_mfma_f32_4x4x4_16b_bf16 v[52:55], v[98:99], v[206:207], v[52:55]
  s_setprio 0
  s_add_u32 m0, s100, 74496
  s_mov_b32 s67, s66
  s_add_u32 s66, s66, s73
  buffer_load_dwordx4 v56, s[12:15], s66 offen offset:0  lds
  s_nop 1
  v_mov_b32_dpp v184, v8 quad_perm:[0,0,0,0] row_mask:0xf bank_mask:0xf
  buffer_load_dwordx4 v56, s[12:15], s66 offen offset:1024  lds
  v_mov_b32_dpp v185, v48 quad_perm:[0,0,0,0] row_mask:0xf bank_mask:0xf
  buffer_load_dwordx4 v56, s[12:15], s66 offen offset:2048  lds
  v_add_f32_dpp v184, v9, v184 quad_perm:[1,1,1,1] row_mask:0xf bank_mask:0xf
  v_add_f32_dpp v185, v49, v185 quad_perm:[1,1,1,1] row_mask:0xf bank_mask:0xf
  s_add_u32 m0, s100, 24832
  s_nop 0
  buffer_load_dwordx4 v56, s[16:19], s67 offen offset:0  lds
  v_add_f32_dpp v184, v10, v184 quad_perm:[2,2,2,2] row_mask:0xf bank_mask:0xf
  buffer_load_dwordx4 v56, s[16:19], s67 offen offset:1024  lds
  v_add_f32_dpp v185, v50, v185 quad_perm:[2,2,2,2] row_mask:0xf bank_mask:0xf
  buffer_load_dwordx4 v56, s[16:19], s67 offen offset:2048  lds
  v_add_f32_dpp v184, v11, v184 quad_perm:[3,3,3,3] row_mask:0xf bank_mask:0xf
  v_add_f32_dpp v185, v51, v185 quad_perm:[3,3,3,3] row_mask:0xf bank_mask:0xf
  s_add_u32 m0, s100, 86912
  s_mov_b32 s67, s66
  s_add_u32 s66, s66, s73
  buffer_load_dwordx4 v56, s[12:15], s66 offen offset:0  lds
  v_add_f32_dpp v184, v12, v184 quad_perm:[0,0,0,0] row_mask:0xf bank_mask:0xf
  buffer_load_dwordx4 v56, s[12:15], s66 offen offset:1024  lds
  v_add_f32_dpp v185, v52, v185 quad_perm:[0,0,0,0] row_mask:0xf bank_mask:0xf
  v_add_f32_dpp v184, v13, v184 quad_perm:[1,1,1,1] row_mask:0xf bank_mask:0xf
  buffer_load_dwordx4 v56, s[12:15], s66 offen offset:2048  lds
  v_add_f32_dpp v185, v53, v185 quad_perm:[1,1,1,1] row_mask:0xf bank_mask:0xf
  s_add_u32 m0, s100, 37248
  s_nop 0
  buffer_load_dwordx4 v56, s[16:19], s67 offen offset:0  lds
  v_add_f32_dpp v184, v14, v184 quad_perm:[2,2,2,2] row_mask:0xf bank_mask:0xf
  v_add_f32_dpp v185, v54, v185 quad_perm:[2,2,2,2] row_mask:0xf bank_mask:0xf
  buffer_load_dwordx4 v56, s[16:19], s67 offen offset:1024  lds
  v_add_f32_dpp v184, v15, v184 quad_perm:[3,3,3,3] row_mask:0xf bank_mask:0xf
  buffer_load_dwordx4 v56, s[16:19], s67 offen offset:2048  lds
  v_add_f32_dpp v185, v55, v185 quad_perm:[3,3,3,3] row_mask:0xf bank_mask:0xf
  s_waitcnt vmcnt(18)
  s_waitcnt lgkmcnt(0)
  s_barrier
  buffer_load_dwordx2 v[16:17], v6, s[4:7], 0 offen offset:60
  v_add_u32 v6, 49152, v6
  v_add_f32_dpp v184, v184, v184 row_half_mirror row_mask:0xf bank_mask:0xf
  v_add_f32_dpp v185, v185, v185 row_half_mirror row_mask:0xf bank_mask:0xf
  v_max_f32 v186, v184, v185
  v_sub_f32 v184, v184, v186
  v_sub_f32 v185, v185, v186
  v_mul_f32 v184, s74, v184
  v_mul_f32 v185, s74, v185
  v_exp_f32 v184, v184
  v_and_b32 v4, 0xffff, v32
  v_mad_u32_u24 v4, v4, s78, v3
  buffer_load_dwordx4 v[64:67], v4, s[24:27], 0 offen offset:0
  s_cmp_gt_u32 s58, 36
  s_cbranch_scc1 L_cs1
  s_call_b64 s[60:61], L_combB
L_cs1:
  buffer_load_dwordx4 v[72:75], v4, s[24:27], 0 offen offset:128
  v_exp_f32 v185, v185
  buffer_load_dwordx4 v[80:83], v4, s[24:27], 0 offen offset:256
  s_nop 0
  v_add_f32 v186, v184, v185
  v_rcp_f32 v186, v186
  s_nop 0
  v_mul_f32 v186, s56, v186
  v_mul_f32 v184, v184, v186
  v_mul_f32 v185, v185, v186
  v_cvt_pk_bf16_f32 v45, v184, v185
  s_waitcnt vmcnt(10)
  s_waitcnt lgkmcnt(0)
  s_barrier
  s_waitcnt lgkmcnt(0)
  s_setprio 3
  v_mfma_f32_4x4x4_16b_bf16 v[8:11], v[136:137], v[232:233], 0
  v_mfma_f32_4x4x4_16b_bf16 v[48:51], v[136:137], v[236:237], 0
  v_mfma_f32_4x4x4_16b_bf16 v[12:15], v[138:139], v[234:235], 0
  v_mfma_f32_4x4x4_16b_bf16 v[52:55], v[138:139], v[238:239], 0
  v_mfma_f32_4x4x4_16b_bf16 v[8:11], v[140:141], v[240:241], v[8:11]
  v_mfma_f32_4x4x4_16b_bf16 v[48:51], v[140:141], v[244:245], v[48:51]
  v_mfma_f32_4x4x4_16b_bf16 v[12:15], v[142:143], v[242:243], v[12:15]
  v_mfma_f32_4x4x4_16b_bf16 v[52:55], v[142:143], v[246:247], v[52:55]
  v_mfma_f32_4x4x4_16b_bf16 v[8:11], v[144:145], v[248:249], v[8:11]
  v_mfma_f32_4x4x4_16b_bf16 v[48:51], v[144:145], v[252:253], v[48:51]
  v_mfma_f32_4x4x4_16b_bf16 v[12:15], v[146:147], v[250:251], v[12:15]
  v_mfma_f32_4x4x4_16b_bf16 v[52:55], v[146:147], v[254:255], v[52:55]
  s_setprio 0
  s_add_u32 m0, s100, 99328
  s_mov_b32 s67, s66
  s_add_u32 s66, s66, s73
  s_cmp_eq_u32 s54, 36
  s_cselect_b32 s66, s95, s66
  s_cselect_b32 s73, 0xffffd000, s73
  buffer_load_dwordx4 v56, s[12:15], s66 offen offset:0  lds
  s_nop 1
  v_mov_b32_dpp v232, v8 quad_perm:[0,0,0,0] row_mask:0xf bank_mask:0xf
  buffer_load_dwordx4 v56, s[12:15], s66 offen offset:1024  lds
  v_mov_b32_dpp v233, v48 quad_perm:[0,0,0,0] row_mask:0xf bank_mask:0xf
  buffer_load_dwordx4 v56, s[12:15], s66 offen offset:2048  lds
  v_add_f32_dpp v232, v9, v232 quad_perm:[1,1,1,1] row_mask:0xf bank_mask:0xf
  v_add_f32_dpp v233, v49, v233 quad_perm:[1,1,1,1] row_mask:0xf bank_mask:0xf
  s_add_u32 m0, s100, 49664
  s_nop 0
  buffer_load_dwordx4 v56, s[16:19], s67 offen offset:0  lds
  v_add_f32_dpp v232, v10, v232 quad_perm:[2,2,2,2] row_mask:0xf bank_mask:0xf
  buffer_load_dwordx4 v56, s[16:19], s67 offen offset:1024  lds
  v_add_f32_dpp v233, v50, v233 quad_perm:[2,2,2,2] row_mask:0xf bank_mask:0xf
  buffer_load_dwordx4 v56, s[16:19], s67 offen offset:2048  lds
  v_add_f32_dpp v232, v11, v232 quad_perm:[3,3,3,3] row_mask:0xf bank_mask:0xf
  v_add_f32_dpp v233, v51, v233 quad_perm:[3,3,3,3] row_mask:0xf bank_mask:0xf
  s_add_u32 m0, s100, 62080
  s_mov_b32 s67, s66
  s_add_u32 s66, s66, s73
  buffer_load_dwordx4 v56, s[12:15], s66 offen offset:0  lds
  v_add_f32_dpp v232, v12, v232 quad_perm:[0,0,0,0] row_mask:0xf bank_mask:0xf
  buffer_load_dwordx4 v56, s[12:15], s66 offen offset:1024  lds
  v_add_f32_dpp v233, v52, v233 quad_perm:[0,0,0,0] row_mask:0xf bank_mask:0xf
  v_add_f32_dpp v232, v13, v232 quad_perm:[1,1,1,1] row_mask:0xf bank_mask:0xf
  buffer_load_dwordx4 v56, s[12:15], s66 offen offset:2048  lds
  v_add_f32_dpp v233, v53, v233 quad_perm:[1,1,1,1] row_mask:0xf bank_mask:0xf
  s_add_u32 m0, s100, 0
  s_nop 0
  buffer_load_dwordx4 v56, s[16:19], s67 offen offset:0  lds
  v_add_f32_dpp v232, v14, v232 quad_perm:[2,2,2,2] row_mask:0xf bank_mask:0xf
  v_add_f32_dpp v233, v54, v233 quad_perm:[2,2,2,2] row_mask:0xf bank_mask:0xf
  buffer_load_dwordx4 v56, s[16:19], s67 offen offset:1024  lds
  v_add_f32_dpp v232, v15, v232 quad_perm:[3,3,3,3] row_mask:0xf bank_mask:0xf
  buffer_load_dwordx4 v56, s[16:19], s67 offen offset:2048  lds
  v_add_f32_dpp v233, v55, v233 quad_perm:[3,3,3,3] row_mask:0xf bank_mask:0xf
  s_waitcnt vmcnt(16)
  s_waitcnt lgkmcnt(0)
  s_barrier
  v_lshrrev_b32 v4, 16, v32
  v_mad_u32_u24 v4, v4, s78, v3
  buffer_load_dwordx4 v[68:71], v4, s[24:27], 0 offen offset:0
  v_add_f32_dpp v232, v232, v232 row_half_mirror row_mask:0xf bank_mask:0xf
  v_add_f32_dpp v233, v233, v233 row_half_mirror row_mask:0xf bank_mask:0xf
  v_max_f32 v234, v232, v233
  v_sub_f32 v232, v232, v234
  buffer_load_dwordx4 v[76:79], v4, s[24:27], 0 offen offset:128
  v_sub_f32 v233, v233, v234
  v_mul_f32 v232, s74, v232
  v_mul_f32 v233, s74, v233
  buffer_load_dwordx4 v[84:87], v4, s[24:27], 0 offen offset:256
  v_exp_f32 v232, v232
  v_exp_f32 v233, v233
  v_and_b32 v4, 0xffff, v33
  v_mad_u32_u24 v4, v4, s78, v3
  buffer_load_dwordx4 v[88:91], v4, s[24:27], 0 offen offset:0
  s_nop 0
  v_add_f32 v234, v232, v233
  v_rcp_f32 v234, v234
  buffer_load_dwordx4 v[96:99], v4, s[24:27], 0 offen offset:128
  s_nop 0
  v_mul_f32 v234, s56, v234
  buffer_load_dwordx4 v[104:107], v4, s[24:27], 0 offen offset:256
  v_mul_f32 v232, v232, v234
  v_mul_f32 v233, v233, v234
  v_cvt_pk_bf16_f32 v47, v232, v233
  s_waitcnt vmcnt(12)
  s_waitcnt lgkmcnt(0)
  s_barrier
  s_add_u32 m0, s100, 74496
  s_mov_b32 s67, s66
  s_add_u32 s66, s66, s73
  buffer_load_dwordx4 v56, s[12:15], s66 offen offset:0  lds
  buffer_load_dwordx4 v56, s[12:15], s66 offen offset:1024  lds
  buffer_load_dwordx4 v56, s[12:15], s66 offen offset:2048  lds
  s_add_u32 m0, s100, 12416
  s_nop 0
  buffer_load_dwordx4 v56, s[16:19], s67 offen offset:0  lds
  buffer_load_dwordx4 v56, s[16:19], s67 offen offset:1024  lds
  buffer_load_dwordx4 v56, s[16:19], s67 offen offset:2048  lds
  s_add_u32 m0, s100, 86912
  s_mov_b32 s67, s66
  s_add_u32 s66, s66, s73
  buffer_load_dwordx4 v56, s[12:15], s66 offen offset:0  lds
  buffer_load_dwordx4 v56, s[12:15], s66 offen offset:1024  lds
  buffer_load_dwordx4 v56, s[12:15], s66 offen offset:2048  lds
  s_add_u32 m0, s100, 24832
  s_nop 0
  buffer_load_dwordx4 v56, s[16:19], s67 offen offset:0  lds
  buffer_load_dwordx4 v56, s[16:19], s67 offen offset:1024  lds
  buffer_load_dwordx4 v56, s[16:19], s67 offen offset:2048  lds
  s_waitcnt vmcnt(18)
  s_waitcnt lgkmcnt(0)
  s_barrier
  buffer_load_dwordx2 v[16:17], v6, s[4:7], 0 offen offset:60
  v_add_u32 v6, 49152, v6
  v_lshrrev_b32 v4, 16, v33
  v_mad_u32_u24 v4, v4, s78, v3
  buffer_load_dwordx4 v[92:95], v4, s[24:27], 0 offen offset:0
  buffer_load_dwordx4 v[100:103], v4, s[24:27], 0 offen offset:128
  buffer_load_dwordx4 v[108:111], v4, s[24:27], 0 offen offset:256
  s_waitcnt vmcnt(10)
  s_waitcnt lgkmcnt(0)
  s_barrier
  v_perm_b32 v59, v40, v40, s92
  v_perm_b32 v61, v40, v40, s93
  v_and_b32 v58, v57, v59
  s_add_u32 m0, s100, 99328
  s_mov_b32 s67, s66
  s_add_u32 s66, s66, s73
  s_cmp_eq_u32 s54, 40
  s_cselect_b32 s66, s95, s66
  s_cselect_b32 s73, 0xffffd000, s73
  buffer_load_dwordx4 v56, s[12:15], s66 offen offset:0  lds
  v_and_b32 v59, v0, v59
  buffer_load_dwordx4 v56, s[12:15], s66 offen offset:1024  lds
  v_and_b32 v60, v57, v61
  buffer_load_dwordx4 v56, s[12:15], s66 offen offset:2048  lds
  v_and_b32 v61, v0, v61
  s_add_u32 m0, s100, 37248
  s_nop 0
  buffer_load_dwordx4 v56, s[16:19], s67 offen offset:0  lds
  buffer_load_dwordx4 v56, s[16:19], s67 offen offset:1024  lds
  s_nop 0
  s_setprio 3
  v_mfma_f32_4x4x4_16b_bf16 v[8:11], v[58:59], v[64:65], 0
  v_mfma_f32_4x4x4_16b_bf16 v[12:15], v[58:59], v[66:67], 0
  v_mfma_f32_4x4x4_16b_bf16 v[48:51], v[58:59], v[72:73], 0
  v_mfma_f32_4x4x4_16b_bf16 v[52:55], v[58:59], v[74:75], 0
  v_mfma_f32_4x4x4_16b_bf16 v[64:67], v[60:61], v[68:69], v[8:11]
  v_mfma_f32_4x4x4_16b_bf16 v[68:71], v[60:61], v[70:71], v[12:15]
  v_mfma_f32_4x4x4_16b_bf16 v[8:11], v[58:59], v[80:81], 0
  v_mfma_f32_4x4x4_16b_bf16 v[12:15], v[58:59], v[82:83], 0
  v_mfma_f32_4x4x4_16b_bf16 v[72:75], v[60:61], v[76:77], v[48:51]
  v_mfma_f32_4x4x4_16b_bf16 v[76:79], v[60:61], v[78:79], v[52:55]
  v_mfma_f32_4x4x4_16b_bf16 v[80:83], v[60:61], v[84:85], v[8:11]
  v_mfma_f32_4x4x4_16b_bf16 v[84:87], v[60:61], v[86:87], v[12:15]
  s_setprio 0
  buffer_load_dwordx4 v56, s[16:19], s67 offen offset:2048  lds
  s_add_u32 m0, s100, 62080
  s_mov_b32 s67, s66
  s_add_u32 s66, s66, s73
  buffer_load_dwordx4 v56, s[12:15], s66 offen offset:0  lds
  buffer_load_dwordx4 v56, s[12:15], s66 offen offset:1024  lds
  buffer_load_dwordx4 v56, s[12:15], s66 offen offset:2048  lds
  s_add_u32 m0, s100, 49664
  s_nop 0
  buffer_load_dwordx4 v56, s[16:19], s67 offen offset:0  lds
  buffer_load_dwordx4 v56, s[16:19], s67 offen offset:1024  lds
  buffer_load_dwordx4 v56, s[16:19], s67 offen offset:2048  lds
  s_waitcnt vmcnt(16)
  s_waitcnt lgkmcnt(0)
  s_barrier
  v_and_b32 v4, 0xffff, v34
  v_mad_u32_u24 v4, v4, s78, v3
  buffer_load_dwordx4 v[112:115], v4, s[24:27], 0 offen offset:0
  s_cmp_gt_u32 s58, 42
  s_cbranch_scc1 L_cs2
  s_call_b64 s[60:61], L_combB
L_cs2:
  buffer_load_dwordx4 v[120:123], v4, s[24:27], 0 offen offset:128
  buffer_load_dwordx4 v[128:131], v4, s[24:27], 0 offen offset:256
  v_lshrrev_b32 v4, 16, v34
  v_mad_u32_u24 v4, v4, s78, v3
  buffer_load_dwordx4 v[116:119], v4, s[24:27], 0 offen offset:0
  buffer_load_dwordx4 v[124:127], v4, s[24:27], 0 offen offset:128
  buffer_load_dwordx4 v[132:135], v4, s[24:27], 0 offen offset:256
  s_waitcnt vmcnt(12)
  s_waitcnt lgkmcnt(0)
  s_barrier
  v_perm_b32 v59, v41, v41, s92
  v_perm_b32 v61, v41, v41, s93
  v_and_b32 v58, v57, v59
  s_add_u32 m0, s100, 74496
  s_mov_b32 s67, s66
  s_add_u32 s66, s66, s73
  buffer_load_dwordx4 v56, s[12:15], s66 offen offset:0  lds
  v_and_b32 v59, v0, v59
  buffer_load_dwordx4 v56, s[12:15], s66 offen offset:1024  lds
  v_and_b32 v60, v57, v61
  buffer_load_dwordx4 v56, s[12:15], s66 offen offset:2048  lds
  v_and_b32 v61, v0, v61
  s_add_u32 m0, s100, 0
  s_nop 0
  buffer_load_dwordx4 v56, s[16:19], s67 offen offset:0  lds
  buffer_load_dwordx4 v56, s[16:19], s67 offen offset:1024  lds
  s_nop 0
  s_setprio 3
  v_mfma_f32_4x4x4_16b_bf16 v[8:11], v[58:59], v[88:89], 0
  v_mfma_f32_4x4x4_16b_bf16 v[12:15], v[58:59], v[90:91], 0
  v_mfma_f32_4x4x4_16b_bf16 v[48:51], v[58:59], v[96:97], 0
  v_mfma_f32_4x4x4_16b_bf16 v[52:55], v[58:59], v[98:99], 0
  v_mfma_f32_4x4x4_16b_bf16 v[88:91], v[60:61], v[92:93], v[8:11]
  v_mfma_f32_4x4x4_16b_bf16 v[92:95], v[60:61], v[94:95], v[12:15]
  v_mfma_f32_4x4x4_16b_bf16 v[8:11], v[58:59], v[104:105], 0
  v_mfma_f32_4x4x4_16b_bf16 v[12:15], v[58:59], v[106:107], 0
  v_mfma_f32_4x4x4_16b_bf16 v[96:99], v[60:61], v[100:101], v[48:51]
  v_mfma_f32_4x4x4_16b_bf16 v[100:103], v[60:61], v[102:103], v[52:55]
  v_mfma_f32_4x4x4_16b_bf16 v[104:107], v[60:61], v[108:109], v[8:11]
  v_mfma_f32_4x4x4_16b_bf16 v[108:111], v[60:61], v[110:111], v[12:15]
  s_setprio 0
  buffer_load_dwordx4 v56, s[16:19], s67 offen offset:2048  lds
  s_add_u32 m0, s100, 86912
  s_mov_b32 s67, s66
  s_add_u32 s66, s66, s73
  buffer_load_dwordx4 v56, s[12:15], s66 offen offset:0  lds
  buffer_load_dwordx4 v56, s[12:15], s66 offen offset:1024  lds
  buffer_load_dwordx4 v56, s[12:15], s66 offen offset:2048  lds
  s_add_u32 m0, s100, 12416
  s_nop 0
  buffer_load_dwordx4 v56, s[16:19], s67 offen offset:0  lds
  buffer_load_dwordx4 v56, s[16:19], s67 offen offset:1024  lds
  buffer_load_dwordx4 v56, s[16:19], s67 offen offset:2048  lds
  s_waitcnt vmcnt(18)
  s_waitcnt lgkmcnt(0)
  s_barrier
  buffer_load_dwordx2 v[16:17], v6, s[4:7], 0 offen offset:60
  v_add_u32 v6, 49152, v6
  s_cmp_gt_u32 s58, 44
  s_cbranch_scc1 L_cs3
  s_call_b64 s[60:61], L_combB
L_cs3:
  v_and_b32 v4, 0xffff, v35
  v_mad_u32_u24 v4, v4, s78, v3
  buffer_load_dwordx4 v[136:139], v4, s[24:27], 0 offen offset:0
  buffer_load_dwordx4 v[144:147], v4, s[24:27], 0 offen offset:128
  buffer_load_dwordx4 v[152:155], v4, s[24:27], 0 offen offset:256
  s_waitcnt vmcnt(10)
  s_waitcnt lgkmcnt(0)
  s_barrier
  v_perm_b32 v59, v42, v42, s92
  v_perm_b32 v61, v42, v42, s93
  v_and_b32 v58, v57, v59
  s_add_u32 m0, s100, 99328
  s_mov_b32 s67, s66
  s_add_u32 s66, s66, s73
  s_cmp_eq_u32 s54, 44
  s_cselect_b32 s66, s95, s66
  s_cselect_b32 s73, 0xffffd000, s73
  buffer_load_dwordx4 v56, s[12:15], s66 offen offset:0  lds
  v_and_b32 v59, v0, v59
  buffer_load_dwordx4 v56, s[12:15], s66 offen offset:1024  lds
  v_and_b32 v60, v57, v61
  buffer_load_dwordx4 v56, s[12:15], s66 offen offset:2048  lds
  v_and_b32 v61, v0, v61
  s_add_u32 m0, s100, 24832
  s_nop 0
  buffer_load_dwordx4 v56, s[16:19], s67 offen offset:0  lds
  buffer_load_dwordx4 v56, s[16:19], s67 offen offset:1024  lds
  s_nop 0
  s_setprio 3
  v_mfma_f32_4x4x4_16b_bf16 v[8:11], v[58:59], v[112:113], 0
  v_mfma_f32_4x4x4_16b_bf16 v[12:15], v[58:59], v[114:115], 0
  v_mfma_f32_4x4x4_16b_bf16 v[48:51], v[58:59], v[120:121], 0
  v_mfma_f32_4x4x4_16b_bf16 v[52:55], v[58:59], v[122:123], 0
  v_mfma_f32_4x4x4_16b_bf16 v[112:115], v[60:61], v[116:117], v[8:11]
  v_mfma_f32_4x4x4_16b_bf16 v[116:119], v[60:61], v[118:119], v[12:15]
  v_mfma_f32_4x4x4_16b_bf16 v[8:11], v[58:59], v[128:129], 0
  v_mfma_f32_4x4x4_16b_bf16 v[12:15], v[58:59], v[130:131], 0
  v_mfma_f32_4x4x4_16b_bf16 v[120:123], v[60:61], v[124:125], v[48:51]
  v_mfma_f32_4x4x4_16b_bf16 v[124:127], v[60:61], v[126:127], v[52:55]
  v_mfma_f32_4x4x4_16b_bf16 v[128:131], v[60:61], v[132:133], v[8:11]
  v_mfma_f32_4x4x4_16b_bf16 v[132:135], v[60:61], v[134:135], v[12:15]
  s_setprio 0
  buffer_load_dwordx4 v56, s[16:19], s67 offen offset:2048  lds
  s_add_u32 m0, s100, 62080
  s_mov_b32 s67, s66
  s_add_u32 s66, s66, s73
  buffer_load_dwordx4 v56, s[12:15], s66 offen offset:0  lds
  buffer_load_dwordx4 v56, s[12:15], s66 offen offset:1024  lds
  buffer_load_dwordx4 v56, s[12:15], s66 offen offset:2048  lds
  s_add_u32 m0, s100, 37248
  s_nop 0
  buffer_load_dwordx4 v56, s[16:19], s67 offen offset:0  lds
  buffer_load_dwordx4 v56, s[16:19], s67 offen offset:1024  lds
  buffer_load_dwordx4 v56, s[16:19], s67 offen offset:2048  lds
  s_waitcnt vmcnt(16)
  s_waitcnt lgkmcnt(0)
  s_barrier
  buffer_load_dwordx2 v[16:17], v6, s[4:7], 0 offen offset:60
  v_add_u32 v6, 49152, v6
  s_cmp_gt_u32 s58, 46
  s_cbranch_scc1 L_cs4
  s_call_b64 s[60:61], L_combB
L_cs4:
  v_lshrrev_b32 v4, 16, v35
  v_mad_u32_u24 v4, v4, s78, v3
  buffer_load_dwordx4 v[140:143], v4, s[24:27], 0 offen offset:0
  buffer_load_dwordx4 v[148:151], v4, s[24:27], 0 offen offset:128
  buffer_load_dwordx4 v[156:159], v4, s[24:27], 0 offen offset:256
  s_waitcnt vmcnt(10)
  s_waitcnt lgkmcnt(0)
  s_barrier
  s_add_u32 m0, s100, 74496
  s_mov_b32 s67, s66
  s_add_u32 s66, s66, s73
  buffer_load_dwordx4 v56, s[12:15], s66 offen offset:0  lds
  buffer_load_dwordx4 v56, s[12:15], s66 offen offset:1024  lds
  buffer_load_dwordx4 v56, s[12:15], s66 offen offset:2048  lds
  s_add_u32 m0, s100, 49664
  s_nop 0
  buffer_load_dwordx4 v56, s[16:19], s67 offen offset:0  lds
  buffer_load_dwordx4 v56, s[16:19], s67 offen offset:1024  lds
  buffer_load_dwordx4 v56, s[16:19], s67 offen offset:2048  lds
  s_add_u32 m0, s100, 86912
  s_mov_b32 s67, s66
  s_add_u32 s66, s66, s73
  buffer_load_dwordx4 v56, s[12:15], s66 offen offset:0  lds
  buffer_load_dwordx4 v56, s[12:15], s66 offen offset:1024  lds
  buffer_load_dwordx4 v56, s[12:15], s66 offen offset:2048  lds
  s_add_u32 m0, s100, 0
  s_nop 0
  buffer_load_dwordx4 v56, s[16:19], s67 offen offset:0  lds
  buffer_load_dwordx4 v56, s[16:19], s67 offen offset:1024  lds
  buffer_load_dwordx4 v56, s[16:19], s67 offen offset:2048  lds
  s_waitcnt vmcnt(16)
  s_waitcnt lgkmcnt(0)
  s_barrier
  v_and_b32 v4, 0xffff, v36
  v_mad_u32_u24 v4, v4, s78, v3
  buffer_load_dwordx4 v[160:163], v4, s[24:27], 0 offen offset:0
  s_cmp_gt_u32 s58, 48
  s_cbranch_scc1 L_cs5
  s_call_b64 s[60:61], L_combB
L_cs5:
  buffer_load_dwordx4 v[168:171], v4, s[24:27], 0 offen offset:128
  buffer_load_dwordx4 v[176:179], v4, s[24:27], 0 offen offset:256
  v_lshrrev_b32 v4, 16, v36
  v_mad_u32_u24 v4, v4, s78, v3
  buffer_load_dwordx4 v[164:167], v4, s[24:27], 0 offen offset:0
  buffer_load_dwordx4 v[172:175], v4, s[24:27], 0 offen offset:128
  buffer_load_dwordx4 v[180:183], v4, s[24:27], 0 offen offset:256
  s_waitcnt vmcnt(12)
  s_waitcnt lgkmcnt(0)
  s_barrier
  v_perm_b32 v59, v43, v43, s92
  v_perm_b32 v61, v43, v43, s93
  v_and_b32 v58, v57, v59
  s_add_u32 m0, s100, 99328
  s_mov_b32 s67, s66
  s_add_u32 s66, s66, s73
  s_cmp_eq_u32 s54, 48
  s_cselect_b32 s66, s95, s66
  s_cselect_b32 s73, 0xffffd000, s73
  buffer_load_dwordx4 v56, s[12:15], s66 offen offset:0  lds
  v_and_b32 v59, v0, v59
  buffer_load_dwordx4 v56, s[12:15], s66 offen offset:1024  lds
  v_and_b32 v60, v57, v61
  buffer_load_dwordx4 v56, s[12:15], s66 offen offset:2048  lds
  v_and_b32 v61, v0, v61
  s_add_u32 m0, s100, 12416
  s_nop 0
  buffer_load_dwordx4 v56, s[16:19], s67 offen offset:0  lds
  buffer_load_dwordx4 v56, s[16:19], s67 offen offset:1024  lds
  s_nop 0
  s_setprio 3
  v_mfma_f32_4x4x4_16b_bf16 v[8:11], v[58:59], v[136:137], 0
  v_mfma_f32_4x4x4_16b_bf16 v[12:15], v[58:59], v[138:139], 0
  v_mfma_f32_4x4x4_16b_bf16 v[48:51], v[58:59], v[144:145], 0
  v_mfma_f32_4x4x4_16b_bf16 v[52:55], v[58:59], v[146:147], 0
  v_mfma_f32_4x4x4_16b_bf16 v[136:139], v[60:61], v[140:141], v[8:11]
  v_mfma_f32_4x4x4_16b_bf16 v[140:143], v[60:61], v[142:143], v[12:15]
  v_mfma_f32_4x4x4_16b_bf16 v[8:11], v[58:59], v[152:153], 0
  v_mfma_f32_4x4x4_16b_bf16 v[12:15], v[58:59], v[154:155], 0
  v_mfma_f32_4x4x4_16b_bf16 v[144:147], v[60:61], v[148:149], v[48:51]
  v_mfma_f32_4x4x4_16b_bf16 v[148:151], v[60:61], v[150:151], v[52:55]
  v_mfma_f32_4x4x4_16b_bf16 v[152:155], v[60:61], v[156:157], v[8:11]
  v_mfma_f32_4x4x4_16b_bf16 v[156:159], v[60:61], v[158:159], v[12:15]
  s_setprio 0
  buffer_load_dwordx4 v56, s[16:19], s67 offen offset:2048  lds
  s_add_u32 m0, s100, 62080
  s_mov_b32 s67, s66
  s_add_u32 s66, s66, s73
  buffer_load_dwordx4 v56, s[12:15], s66 offen offset:0  lds
  buffer_load_dwordx4 v56, s[12:15], s66 offen offset:1024  lds
  buffer_load_dwordx4 v56, s[12:15], s66 offen offset:2048  lds
  s_add_u32 m0, s100, 24832
  s_nop 0
  buffer_load_dwordx4 v56, s[16:19], s67 offen offset:0  lds
  buffer_load_dwordx4 v56, s[16:19], s67 offen offset:1024  lds
  buffer_load_dwordx4 v56, s[16:19], s67 offen offset:2048  lds
  s_waitcnt vmcnt(18)
  s_waitcnt lgkmcnt(0)
  s_barrier
  buffer_load_dwordx2 v[16:17], v6, s[4:7], 0 offen offset:60
  v_add_u32 v6, 49152, v6
  s_cmp_gt_u32 s58, 50
  s_cbranch_scc1 L_cs6
  s_call_b64 s[60:61], L_combB
L_cs6:
  v_and_b32 v4, 0xffff, v37
  v_mad_u32_u24 v4, v4, s78, v3
  buffer_load_dwordx4 v[184:187], v4, s[24:27], 0 offen offset:0
  buffer_load_dwordx4 v[192:195], v4, s[24:27], 0 offen offset:128
  buffer_load_dwordx4 v[200:203], v4, s[24:27], 0 offen offset:256
  s_waitcnt vmcnt(10)
  s_waitcnt lgkmcnt(0)
  s_barrier
  v_perm_b32 v59, v44, v44, s92
  v_perm_b32 v61, v44, v44, s93
  v_and_b32 v58, v57, v59
  s_add_u32 m0, s100, 74496
  s_mov_b32 s67, s66
  s_add_u32 s66, s66, s73
  buffer_load_dwordx4 v56, s[12:15], s66 offen offset:0  lds
  v_and_b32 v59, v0, v59
  buffer_load_dwordx4 v56, s[12:15], s66 offen offset:1024  lds
  v_and_b32 v60, v57, v61
  buffer_load_dwordx4 v56, s[12:15], s66 offen offset:2048  lds
  v_and_b32 v61, v0, v61
  s_add_u32 m0, s100, 37248
  s_nop 0
  buffer_load_dwordx4 v56, s[16:19], s67 offen offset:0  lds
  s_nop 0
  s_setprio 3
  v_mfma_f32_4x4x4_16b_bf16 v[8:11], v[58:59], v[160:161], 0
  v_mfma_f32_4x4x4_16b_bf16 v[12:15], v[58:59], v[162:163], 0
  v_mfma_f32_4x4x4_16b_bf16 v[48:51], v[58:59], v[168:169], 0
  v_mfma_f32_4x4x4_16b_bf16 v[52:55], v[58:59], v[170:171], 0
  v_mfma_f32_4x4x4_16b_bf16 v[160:163], v[60:61], v[164:165], v[8:11]
  v_mfma_f32_4x4x4_16b_bf16 v[164:167], v[60:61], v[166:167], v[12:15]
  v_mfma_f32_4x4x4_16b_bf16 v[8:11], v[58:59], v[176:177], 0
  v_mfma_f32_4x4x4_16b_bf16 v[12:15], v[58:59], v[178:179], 0
  v_mfma_f32_4x4x4_16b_bf16 v[168:171], v[60:61], v[172:173], v[48:51]
  v_mfma_f32_4x4x4_16b_bf16 v[172:175], v[60:61], v[174:175], v[52:55]
  v_mfma_f32_4x4x4_16b_bf16 v[176:179], v[60:61], v[180:181], v[8:11]
  v_mfma_f32_4x4x4_16b_bf16 v[180:183], v[60:61], v[182:183], v[12:15]
  s_setprio 0
  buffer_load_dwordx4 v56, s[16:19], s67 offen offset:1024  lds
  buffer_load_dwordx4 v56, s[16:19], s67 offen offset:2048  lds
  s_add_u32 m0, s100, 86912
  s_mov_b32 s67, s66
  s_add_u32 s66, s66, s73
  buffer_load_dwordx4 v56, s[12:15], s66 offen offset:0  lds
  buffer_load_dwordx4 v56, s[12:15], s66 offen offset:1024  lds
  buffer_load_dwordx4 v56, s[12:15], s66 offen offset:2048  lds
  s_waitcnt vmcnt(13)
  s_waitcnt lgkmcnt(0)
  s_barrier
  s_add_u32 m0, s100, 49664
  s_nop 0
  buffer_load_dwordx4 v56, s[16:19], s67 offen offset:0  lds
  s_cmp_gt_u32 s58, 52
  s_cbranch_scc1 L_cs7
  s_call_b64 s[60:61], L_combB
L_cs7:
  buffer_load_dwordx4 v56, s[16:19], s67 offen offset:1024  lds
  buffer_load_dwordx4 v56, s[16:19], s67 offen offset:2048  lds
  s_add_u32 m0, s100, 99328
  s_mov_b32 s67, s66
  s_add_u32 s66, s66, s73
  s_cmp_eq_u32 s54, 52
  s_cselect_b32 s66, s95, s66
  s_cselect_b32 s73, 0xffffd000, s73
  buffer_load_dwordx4 v56, s[12:15], s66 offen offset:0  lds
  buffer_load_dwordx4 v56, s[12:15], s66 offen offset:1024  lds
  buffer_load_dwordx4 v56, s[12:15], s66 offen offset:2048  lds
  s_add_u32 m0, s100, 0
  s_nop 0
  buffer_load_dwordx4 v56, s[16:19], s67 offen offset:0  lds
  buffer_load_dwordx4 v56, s[16:19], s67 offen offset:1024  lds
  buffer_load_dwordx4 v56, s[16:19], s67 offen offset:2048  lds
  s_waitcnt vmcnt(12)
  s_waitcnt lgkmcnt(0)
  s_barrier
  buffer_load_dwordx2 v[16:17], v6, s[4:7], 0 offen offset:60
  v_add_u32 v6, 49152, v6
  v_lshrrev_b32 v4, 16, v37
  v_mad_u32_u24 v4, v4, s78, v3
  buffer_load_dwordx4 v[188:191], v4, s[24:27], 0 offen offset:0
  buffer_load_dwordx4 v[196:199], v4, s[24:27], 0 offen offset:128
  buffer_load_dwordx4 v[204:207], v4, s[24:27], 0 offen offset:256
  s_waitcnt vmcnt(10)
  s_waitcnt lgkmcnt(0)
  s_barrier
  s_cmp_gt_u32 s58, 54
  s_cbranch_scc1 L_cs8
  s_call_b64 s[60:61], L_combB
L_cs8:
  s_add_u32 m0, s100, 62080
  s_mov_b32 s67, s66
  s_add_u32 s66, s66, s73
  buffer_load_dwordx4 v56, s[12:15], s66 offen offset:0  lds
  buffer_load_dwordx4 v56, s[12:15], s66 offen offset:1024  lds
  buffer_load_dwordx4 v56, s[12:15], s66 offen offset:2048  lds
  s_add_u32 m0, s100, 12416
  s_nop 0
  buffer_load_dwordx4 v56, s[16:19], s67 offen offset:0  lds
  buffer_load_dwordx4 v56, s[16:19], s67 offen offset:1024  lds
  buffer_load_dwordx4 v56, s[16:19], s67 offen offset:2048  lds
  s_add_u32 m0, s100, 74496
  s_mov_b32 s67, s66
  s_add_u32 s66, s66, s73
  buffer_load_dwordx4 v56, s[12:15], s66 offen offset:0  lds
  buffer_load_dwordx4 v56, s[12:15], s66 offen offset:1024  lds
  buffer_load_dwordx4 v56, s[12:15], s66 offen offset:2048  lds
  s_waitcnt vmcnt(13)
  s_waitcnt lgkmcnt(0)
  s_barrier
  s_add_u32 m0, s100, 24832
  s_nop 0
  buffer_load_dwordx4 v56, s[16:19], s67 offen offset:0  lds
  buffer_load_dwordx4 v56, s[16:19], s67 offen offset:1024  lds
  buffer_load_dwordx4 v56, s[16:19], s67 offen offset:2048  lds
  s_add_u32 m0, s100, 86912
  s_mov_b32 s67, s66
  s_add_u32 s66, s66, s73
  buffer_load_dwordx4 v56, s[12:15], s66 offen offset:0  lds
  buffer_load_dwordx4 v56, s[12:15], s66 offen offset:1024  lds
  buffer_load_dwordx4 v56, s[12:15], s66 offen offset:2048  lds
  s_add_u32 m0, s100, 37248
  s_nop 0
  buffer_load_dwordx4 v56, s[16:19], s67 offen offset:0  lds
  buffer_load_dwordx4 v56, s[16:19], s67 offen offset:1024  lds
  buffer_load_dwordx4 v56, s[16:19], s67 offen offset:2048  lds
  s_waitcnt vmcnt(12)
  s_waitcnt lgkmcnt(0)
  s_barrier
  v_and_b32 v4, 0xffff, v38
  v_mad_u32_u24 v4, v4, s78, v3
  buffer_load_dwordx4 v[208:211], v4, s[24:27], 0 offen offset:0
  v_perm_b32 v59, v45, v45, s92
  v_perm_b32 v61, v45, v45, s93
  v_and_b32 v58, v57, v59
  v_and_b32 v59, v0, v59
  s_cmp_gt_u32 s58, 56
  s_cbranch_scc1 L_cs9
  s_call_b64 s[60:61], L_combB
L_cs9:
  buffer_load_dwordx4 v[216:219], v4, s[24:27], 0 offen offset:128
  buffer_load_dwordx4 v[224:227], v4, s[24:27], 0 offen offset:256
  v_lshrrev_b32 v4, 16, v38
  v_mad_u32_u24 v4, v4, s78, v3
  buffer_load_dwordx4 v[212:215], v4, s[24:27], 0 offen offset:0
  buffer_load_dwordx4 v[220:223], v4, s[24:27], 0 offen offset:128
  v_and_b32 v60, v57, v61
  v_and_b32 v61, v0, v61
  s_nop 0
  s_setprio 3
  v_mfma_f32_4x4x4_16b_bf16 v[8:11], v[58:59], v[184:185], 0
  v_mfma_f32_4x4x4_16b_bf16 v[12:15], v[58:59], v[186:187], 0
  v_mfma_f32_4x4x4_16b_bf16 v[48:51], v[58:59], v[192:193], 0
  v_mfma_f32_4x4x4_16b_bf16 v[52:55], v[58:59], v[194:195], 0
  v_mfma_f32_4x4x4_16b_bf16 v[184:187], v[60:61], v[188:189], v[8:11]
  v_mfma_f32_4x4x4_16b_bf16 v[188:191], v[60:61], v[190:191], v[12:15]
  v_mfma_f32_4x4x4_16b_bf16 v[8:11], v[58:59], v[200:201], 0
  v_mfma_f32_4x4x4_16b_bf16 v[12:15], v[58:59], v[202:203], 0
  v_mfma_f32_4x4x4_16b_bf16 v[192:195], v[60:61], v[196:197], v[48:51]
  v_mfma_f32_4x4x4_16b_bf16 v[196:199], v[60:61], v[198:199], v[52:55]
  v_mfma_f32_4x4x4_16b_bf16 v[200:203], v[60:61], v[204:205], v[8:11]
  v_mfma_f32_4x4x4_16b_bf16 v[204:207], v[60:61], v[206:207], v[12:15]
  s_setprio 0
  buffer_load_dwordx4 v[228:231], v4, s[24:27], 0 offen offset:256
  s_waitcnt vmcnt(12)
  s_waitcnt lgkmcnt(0)
  s_barrier
  s_add_u32 m0, s100, 99328
  s_mov_b32 s67, s66
  s_add_u32 s66, s66, s73
  s_cmp_eq_u32 s54, 56
  s_cselect_b32 s66, s95, s66
  s_cselect_b32 s73, 0xffffd000, s73
  buffer_load_dwordx4 v56, s[12:15], s66 offen offset:0  lds
  buffer_load_dwordx4 v56, s[12:15], s66 offen offset:1024  lds
  buffer_load_dwordx4 v56, s[12:15], s66 offen offset:2048  lds
  s_add_u32 m0, s100, 49664
  s_nop 0
  buffer_load_dwordx4 v56, s[16:19], s67 offen offset:0  lds
  buffer_load_dwordx4 v56, s[16:19], s67 offen offset:1024  lds
  buffer_load_dwordx4 v56, s[16:19], s67 offen offset:2048  lds
  s_add_u32 m0, s100, 62080
  s_mov_b32 s67, s66
  s_add_u32 s66, s66, s73
  buffer_load_dwordx4 v56, s[12:15], s66 offen offset:0  lds
  buffer_load_dwordx4 v56, s[12:15], s66 offen offset:1024  lds
  buffer_load_dwordx4 v56, s[12:15], s66 offen offset:2048  lds
  s_waitcnt vmcnt(15)
  s_waitcnt lgkmcnt(0)
  s_barrier
  s_add_u32 m0, s100, 0
  s_nop 0
  buffer_load_dwordx4 v56, s[16:19], s67 offen offset:0  lds
  s_cmp_gt_u32 s58, 58
  s_cbranch_scc1 L_cs10
  s_call_b64 s[60:61], L_combB
L_cs10:
  buffer_load_dwordx4 v56, s[16:19], s67 offen offset:1024  lds
  buffer_load_dwordx4 v56, s[16:19], s67 offen offset:2048  lds
  s_add_u32 m0, s100, 74496
  s_mov_b32 s67, s66
  s_add_u32 s66, s66, s73
  buffer_load_dwordx4 v56, s[12:15], s66 offen offset:0  lds
  buffer_load_dwordx4 v56, s[12:15], s66 offen offset:1024  lds
  buffer_load_dwordx4 v56, s[12:15], s66 offen offset:2048  lds
  s_add_u32 m0, s100, 12416
  s_nop 0
  buffer_load_dwordx4 v56, s[16:19], s67 offen offset:0  lds
  buffer_load_dwordx4 v56, s[16:19], s67 offen offset:1024  lds
  buffer_load_dwordx4 v56, s[16:19], s67 offen offset:2048  lds
  s_waitcnt vmcnt(12)
  s_waitcnt lgkmcnt(0)
  s_barrier
  v_and_b32 v4, 0xffff, v39
  v_mad_u32_u24 v4, v4, s78, v3
  buffer_load_dwordx4 v[232:235], v4, s[24:27], 0 offen offset:0
  v_perm_b32 v59, v46, v46, s92
  v_perm_b32 v61, v46, v46, s93
  buffer_load_dwordx4 v[240:243], v4, s[24:27], 0 offen offset:128
  v_and_b32 v58, v57, v59
  v_and_b32 v59, v0, v59
  buffer_load_dwordx4 v[248:251], v4, s[24:27], 0 offen offset:256
  v_and_b32 v60, v57, v61
  v_and_b32 v61, v0, v61
  v_lshrrev_b32 v4, 16, v39
  v_mad_u32_u24 v4, v4, s78, v3
  buffer_load_dwordx4 v[236:239], v4, s[24:27], 0 offen offset:0
  s_nop 0
  s_setprio 3
  v_mfma_f32_4x4x4_16b_bf16 v[8:11], v[58:59], v[208:209], 0
  v_mfma_f32_4x4x4_16b_bf16 v[12:15], v[58:59], v[210:211], 0
  v_mfma_f32_4x4x4_16b_bf16 v[48:51], v[58:59], v[216:217], 0
  v_mfma_f32_4x4x4_16b_bf16 v[52:55], v[58:59], v[218:219], 0
  v_mfma_f32_4x4x4_16b_bf16 v[208:211], v[60:61], v[212:213], v[8:11]
  v_mfma_f32_4x4x4_16b_bf16 v[212:215], v[60:61], v[214:215], v[12:15]
  v_mfma_f32_4x4x4_16b_bf16 v[8:11], v[58:59], v[224:225], 0
  v_mfma_f32_4x4x4_16b_bf16 v[12:15], v[58:59], v[226:227], 0
  v_mfma_f32_4x4x4_16b_bf16 v[216:219], v[60:61], v[220:221], v[48:51]
  v_mfma_f32_4x4x4_16b_bf16 v[220:223], v[60:61], v[222:223], v[52:55]
  v_mfma_f32_4x4x4_16b_bf16 v[224:227], v[60:61], v[228:229], v[8:11]
  v_mfma_f32_4x4x4_16b_bf16 v[228:231], v[60:61], v[230:231], v[12:15]
  s_setprio 0
  buffer_load_dwordx4 v[244:247], v4, s[24:27], 0 offen offset:128
  buffer_load_dwordx4 v[252:255], v4, s[24:27], 0 offen offset:256
  s_waitcnt vmcnt(12)
  s_waitcnt lgkmcnt(0)
  s_barrier
  s_cmp_gt_u32 s58, 60
  s_cbranch_scc1 L_cs11
  s_call_b64 s[60:61], L_combB
L_cs11:
  s_add_u32 m0, s100, 86912
  s_mov_b32 s67, s66
  s_add_u32 s66, s66, s73
  buffer_load_dwordx4 v56, s[12:15], s66 offen offset:0  lds
  buffer_load_dwordx4 v56, s[12:15], s66 offen offset:1024  lds
  buffer_load_dwordx4 v56, s[12:15], s66 offen offset:2048  lds
  s_add_u32 m0, s100, 24832
  s_nop 0
  buffer_load_dwordx4 v56, s[16:19], s67 offen offset:0  lds
  buffer_load_dwordx4 v56, s[16:19], s67 offen offset:1024  lds
  buffer_load_dwordx4 v56, s[16:19], s67 offen offset:2048  lds
  s_add_u32 m0, s100, 99328
  s_mov_b32 s67, s66
  s_add_u32 s66, s66, s73
  s_cmp_eq_u32 s54, 60
  s_cselect_b32 s66, s95, s66
  s_cselect_b32 s73, 0xffffd000, s73
  buffer_load_dwordx4 v56, s[12:15], s66 offen offset:0  lds
  buffer_load_dwordx4 v56, s[12:15], s66 offen offset:1024  lds
  s_waitcnt vmcnt(14)
  s_waitcnt lgkmcnt(0)
  s_barrier
  buffer_load_dwordx4 v56, s[12:15], s66 offen offset:2048  lds
  s_add_u32 m0, s100, 37248
  s_nop 0
  buffer_load_dwordx4 v56, s[16:19], s67 offen offset:0  lds
  buffer_load_dwordx4 v56, s[16:19], s67 offen offset:1024  lds
  buffer_load_dwordx4 v56, s[16:19], s67 offen offset:2048  lds
  s_add_u32 m0, s100, 62080
  s_mov_b32 s67, s66
  s_add_u32 s66, s66, s73
  buffer_load_dwordx4 v56, s[12:15], s66 offen offset:0  lds
  buffer_load_dwordx4 v56, s[12:15], s66 offen offset:1024  lds
  buffer_load_dwordx4 v56, s[12:15], s66 offen offset:2048  lds
  s_add_u32 m0, s100, 49664
  s_nop 0
  buffer_load_dwordx4 v56, s[16:19], s67 offen offset:0  lds
  s_waitcnt vmcnt(10)
  s_waitcnt lgkmcnt(0)
  s_barrier
  buffer_load_dwordx4 v56, s[16:19], s67 offen offset:1024  lds
  v_perm_b32 v59, v47, v47, s92
  v_perm_b32 v61, v47, v47, s93
  v_and_b32 v58, v57, v59
  v_and_b32 v59, v0, v59
  buffer_load_dwordx4 v56, s[16:19], s67 offen offset:2048  lds
  s_cmp_gt_u32 s58, 62
  s_cbranch_scc1 L_cs12
  s_call_b64 s[60:61], L_combB
L_cs12:
  s_add_u32 m0, s100, 74496
  s_mov_b32 s67, s66
  s_add_u32 s66, s66, s73
  buffer_load_dwordx4 v56, s[12:15], s66 offen offset:0  lds
  buffer_load_dwordx4 v56, s[12:15], s66 offen offset:1024  lds
  buffer_load_dwordx4 v56, s[12:15], s66 offen offset:2048  lds
  s_add_u32 m0, s100, 0
  s_nop 0
  buffer_load_dwordx4 v56, s[16:19], s67 offen offset:0  lds
  v_and_b32 v60, v57, v61
  v_and_b32 v61, v0, v61
  buffer_load_dwordx4 v56, s[16:19], s67 offen offset:1024  lds
  s_nop 0
  s_setprio 3
  v_mfma_f32_4x4x4_16b_bf16 v[8:11], v[58:59], v[232:233], 0
  v_mfma_f32_4x4x4_16b_bf16 v[12:15], v[58:59], v[234:235], 0
  v_mfma_f32_4x4x4_16b_bf16 v[48:51], v[58:59], v[240:241], 0
  v_mfma_f32_4x4x4_16b_bf16 v[52:55], v[58:59], v[242:243], 0
  v_mfma_f32_4x4x4_16b_bf16 v[232:235], v[60:61], v[236:237], v[8:11]
  v_mfma_f32_4x4x4_16b_bf16 v[236:239], v[60:61], v[238:239], v[12:15]
  v_mfma_f32_4x4x4_16b_bf16 v[8:11], v[58:59], v[248:249], 0
  v_mfma_f32_4x4x4_16b_bf16 v[12:15], v[58:59], v[250:251], 0
  v_mfma_f32_4x4x4_16b_bf16 v[240:243], v[60:61], v[244:245], v[48:51]
  v_mfma_f32_4x4x4_16b_bf16 v[244:247], v[60:61], v[246:247], v[52:55]
  v_mfma_f32_4x4x4_16b_bf16 v[248:251], v[60:61], v[252:253], v[8:11]
  v_mfma_f32_4x4x4_16b_bf16 v[252:255], v[60:61], v[254:255], v[12:15]
  s_setprio 0
  buffer_load_dwordx4 v56, s[16:19], s67 offen offset:2048  lds
  s_waitcnt vmcnt(12)
  s_waitcnt lgkmcnt(0)
  s_barrier
  s_add_u32 m0, s100, 86912
  s_mov_b32 s67, s66
  s_add_u32 s66, s66, s73
  buffer_load_dwordx4 v56, s[12:15], s66 offen offset:0  lds
  s_cmp_gt_u32 s58, 63
  s_cbranch_scc1 L_cs13
  s_call_b64 s[60:61], L_combB
L_cs13:
  buffer_load_dwordx4 v56, s[12:15], s66 offen offset:1024  lds
  buffer_load_dwordx4 v56, s[12:15], s66 offen offset:2048  lds
  s_add_u32 m0, s100, 12416
  s_nop 0
  buffer_load_dwordx4 v56, s[16:19], s67 offen offset:0  lds
  s_cmp_gt_u32 s58, 63
  s_cbranch_scc1 L_cs14
  s_call_b64 s[60:61], L_combB
L_cs14:
  buffer_load_dwordx4 v56, s[16:19], s67 offen offset:1024  lds
  buffer_load_dwordx4 v56, s[16:19], s67 offen offset:2048  lds
  s_waitcnt vmcnt(12)
  s_waitcnt lgkmcnt(0)
  s_barrier
  s_add_u32 m0, s100, 24832
  s_nop 0
  buffer_load_dwordx4 v56, s[16:19], s66 offen offset:0  lds
  s_cmp_gt_u32 s58, 64
  s_cbranch_scc1 L_cs15
  s_call_b64 s[60:61], L_combB
L_cs15:
  buffer_load_dwordx4 v56, s[16:19], s66 offen offset:1024  lds
  s_cmp_gt_u32 s58, 64
  s_cbranch_scc1 L_cs16
  s_call_b64 s[60:61], L_combB
L_cs16:
  buffer_load_dwordx4 v56, s[16:19], s66 offen offset:2048  lds
  s_cmp_gt_u32 s58, 64
  s_cbranch_scc1 L_cs17
  s_call_b64 s[60:61], L_combB
L_cs17:
  s_waitcnt vmcnt(9)
  s_waitcnt lgkmcnt(0)
  s_barrier
  s_cmp_gt_u32 s58, 65
  s_cbranch_scc1 L_cs18
  s_call_b64 s[60:61], L_combB
L_cs18:
  s_cmp_gt_u32 s58, 65
  s_cbranch_scc1 L_cs19
  s_call_b64 s[60:61], L_combB
L_cs19:
  s_cmp_gt_u32 s58, 65
  s_cbranch_scc1 L_cs20
  s_call_b64 s[60:61], L_combB
L_cs20:
  s_waitcnt vmcnt(3)
  s_waitcnt lgkmcnt(0)
  s_barrier
  s_cmp_gt_u32 s58, 66
  s_cbranch_scc1 L_cs21
  s_call_b64 s[60:61], L_combB
L_cs21:
  s_cmp_gt_u32 s58, 66
  s_cbranch_scc1 L_cs22
  s_call_b64 s[60:61], L_combB
L_cs22:
  s_cmp_gt_u32 s58, 66
  s_cbranch_scc1 L_cs23
  s_call_b64 s[60:61], L_combB
L_cs23:
  s_waitcnt vmcnt(0)
  s_waitcnt lgkmcnt(0)
  s_barrier
L_tail_done:
  s_cmp_gt_u32 s58, 67
  s_cbranch_scc1 L_cs24
  s_call_b64 s[60:61], L_combB
L_cs24:
  s_cmp_gt_u32 s58, 67
  s_cbranch_scc1 L_cs25
  s_call_b64 s[60:61], L_combB
L_cs25:
  s_cmp_gt_u32 s58, 67
  s_cbranch_scc1 L_cs26
  s_call_b64 s[60:61], L_combB
L_cs26:
  s_setprio 3
  s_waitcnt lgkmcnt(0)
  s_barrier
  ds_read_b64 v[40:41], v7 offset:384
  ds_read_b64 v[42:43], v7 offset:3584
  ds_read_b64 v[44:45], v7 offset:6848
  ds_read_b64 v[46:47], v7 offset:10048
  ds_read_b128 v[8:11], v2 offset:0
  ds_read_b128 v[12:15], v2 offset:3200
  ds_read_b128 v[32:35], v2 offset:6464
  ds_read_b128 v[36:39], v2 offset:9664
  s_waitcnt lgkmcnt(4)
  v_and_b32 v48, v57, v40
  v_and_b32 v49, v0, v40
  v_and_b32 v50, v57, v42
  v_and_b32 v51, v0, v42
  v_and_b32 v52, v57, v44
  v_and_b32 v53, v0, v44
  v_and_b32 v54, v57, v46
  v_and_b32 v55, v0, v46
  s_waitcnt lgkmcnt(3)
  v_mfma_f32_4x4x4_16b_bf16 v[160:163], v[48:49], v[8:9], v[160:163]
  v_mfma_f32_4x4x4_16b_bf16 v[164:167], v[48:49], v[10:11], v[164:167]
  s_waitcnt lgkmcnt(2)
  v_mfma_f32_4x4x4_16b_bf16 v[184:187], v[50:51], v[14:15], v[184:187]
  v_mfma_f32_4x4x4_16b_bf16 v[188:191], v[50:51], v[12:13], v[188:191]
  s_waitcnt lgkmcnt(1)
  v_mfma_f32_4x4x4_16b_bf16 v[208:211], v[52:53], v[32:33], v[208:211]
  v_mfma_f32_4x4x4_16b_bf16 v[212:215], v[52:53], v[34:35], v[212:215]
  s_waitcnt lgkmcnt(0)
  v_mfma_f32_4x4x4_16b_bf16 v[232:235], v[54:55], v[38:39], v[232:235]
  v_mfma_f32_4x4x4_16b_bf16 v[236:239], v[54:55], v[36:37], v[236:239]
  v_cvt_pk_bf16_f32 v160, v160, v161
  v_cvt_pk_bf16_f32 v161, v162, v163
  v_cvt_pk_bf16_f32 v162, v164, v165
  v_cvt_pk_bf16_f32 v163, v166, v167
  buffer_store_dwordx4 v[160:163], v1, s[32:35], s69 offen offset:0 sc0 sc1 nt
  v_cvt_pk_bf16_f32 v184, v184, v185
  v_cvt_pk_bf16_f32 v185, v186, v187
  v_cvt_pk_bf16_f32 v186, v188, v189
  v_cvt_pk_bf16_f32 v187, v190, v191
  buffer_store_dwordx4 v[184:187], v1, s[32:35], s69 offen offset:3072 sc0 sc1 nt
  v_cvt_pk_bf16_f32 v208, v208, v209
  v_cvt_pk_bf16_f32 v209, v210, v211
  v_cvt_pk_bf16_f32 v210, v212, v213
  v_cvt_pk_bf16_f32 v211, v214, v215
  buffer_store_dwordx4 v[208:211], v1, s[32:35], s77 offen offset:0 sc0 sc1 nt
  v_cvt_pk_bf16_f32 v232, v232, v233
  v_cvt_pk_bf16_f32 v233, v234, v235
  v_cvt_pk_bf16_f32 v234, v236, v237
  v_cvt_pk_bf16_f32 v235, v238, v239
  buffer_store_dwordx4 v[232:235], v1, s[32:35], s77 offen offset:3072 sc0 sc1 nt
  s_barrier
  ds_read_b128 v[8:11], v2 offset:128
  ds_read_b128 v[12:15], v2 offset:3328
  ds_read_b128 v[32:35], v2 offset:6592
  ds_read_b128 v[36:39], v2 offset:9792
  s_waitcnt lgkmcnt(3)
  v_mfma_f32_4x4x4_16b_bf16 v[168:171], v[48:49], v[8:9], v[168:171]
  v_mfma_f32_4x4x4_16b_bf16 v[172:175], v[48:49], v[10:11], v[172:175]
  s_waitcnt lgkmcnt(2)
  v_mfma_f32_4x4x4_16b_bf16 v[192:195], v[50:51], v[14:15], v[192:195]
  v_mfma_f32_4x4x4_16b_bf16 v[196:199], v[50:51], v[12:13], v[196:199]
  s_waitcnt lgkmcnt(1)
  v_mfma_f32_4x4x4_16b_bf16 v[216:219], v[52:53], v[32:33], v[216:219]
  v_mfma_f32_4x4x4_16b_bf16 v[220:223], v[52:53], v[34:35], v[220:223]
  s_waitcnt lgkmcnt(0)
  v_mfma_f32_4x4x4_16b_bf16 v[240:243], v[54:55], v[38:39], v[240:243]
  v_mfma_f32_4x4x4_16b_bf16 v[244:247], v[54:55], v[36:37], v[244:247]
  v_cvt_pk_bf16_f32 v168, v168, v169
  v_cvt_pk_bf16_f32 v169, v170, v171
  v_cvt_pk_bf16_f32 v170, v172, v173
  v_cvt_pk_bf16_f32 v171, v174, v175
  buffer_store_dwordx4 v[168:171], v1, s[32:35], s69 offen offset:128 sc0 sc1 nt
  v_cvt_pk_bf16_f32 v192, v192, v193
  v_cvt_pk_bf16_f32 v193, v194, v195
  v_cvt_pk_bf16_f32 v194, v196, v197
  v_cvt_pk_bf16_f32 v195, v198, v199
  buffer_store_dwordx4 v[192:195], v1, s[32:35], s69 offen offset:3200 sc0 sc1 nt
  v_cvt_pk_bf16_f32 v216, v216, v217
  v_cvt_pk_bf16_f32 v217, v218, v219
  v_cvt_pk_bf16_f32 v218, v220, v221
  v_cvt_pk_bf16_f32 v219, v222, v223
  buffer_store_dwordx4 v[216:219], v1, s[32:35], s77 offen offset:128 sc0 sc1 nt
  v_cvt_pk_bf16_f32 v240, v240, v241
  v_cvt_pk_bf16_f32 v241, v242, v243
  v_cvt_pk_bf16_f32 v242, v244, v245
  v_cvt_pk_bf16_f32 v243, v246, v247
  buffer_store_dwordx4 v[240:243], v1, s[32:35], s77 offen offset:3200 sc0 sc1 nt
  s_barrier
  ds_read_b128 v[8:11], v2 offset:256
  ds_read_b128 v[12:15], v2 offset:3456
  ds_read_b128 v[32:35], v2 offset:6720
  ds_read_b128 v[36:39], v2 offset:9920
  s_waitcnt lgkmcnt(3)
  v_mfma_f32_4x4x4_16b_bf16 v[176:179], v[48:49], v[8:9], v[176:179]
  v_mfma_f32_4x4x4_16b_bf16 v[180:183], v[48:49], v[10:11], v[180:183]
  s_waitcnt lgkmcnt(2)
  v_mfma_f32_4x4x4_16b_bf16 v[200:203], v[50:51], v[14:15], v[200:203]
  v_mfma_f32_4x4x4_16b_bf16 v[204:207], v[50:51], v[12:13], v[204:207]
  s_waitcnt lgkmcnt(1)
  v_mfma_f32_4x4x4_16b_bf16 v[224:227], v[52:53], v[32:33], v[224:227]
  v_mfma_f32_4x4x4_16b_bf16 v[228:231], v[52:53], v[34:35], v[228:231]
  s_waitcnt lgkmcnt(0)
  v_mfma_f32_4x4x4_16b_bf16 v[248:251], v[54:55], v[38:39], v[248:251]
  v_mfma_f32_4x4x4_16b_bf16 v[252:255], v[54:55], v[36:37], v[252:255]
  v_cvt_pk_bf16_f32 v176, v176, v177
  v_cvt_pk_bf16_f32 v177, v178, v179
  v_cvt_pk_bf16_f32 v178, v180, v181
  v_cvt_pk_bf16_f32 v179, v182, v183
  buffer_store_dwordx4 v[176:179], v1, s[32:35], s69 offen offset:256 sc0 sc1 nt
  v_cvt_pk_bf16_f32 v200, v200, v201
  v_cvt_pk_bf16_f32 v201, v202, v203
  v_cvt_pk_bf16_f32 v202, v204, v205
  v_cvt_pk_bf16_f32 v203, v206, v207
  buffer_store_dwordx4 v[200:203], v1, s[32:35], s69 offen offset:3328 sc0 sc1 nt
  v_cvt_pk_bf16_f32 v224, v224, v225
  v_cvt_pk_bf16_f32 v225, v226, v227
  v_cvt_pk_bf16_f32 v226, v228, v229
  v_cvt_pk_bf16_f32 v227, v230, v231
  buffer_store_dwordx4 v[224:227], v1, s[32:35], s77 offen offset:256 sc0 sc1 nt
  v_cvt_pk_bf16_f32 v248, v248, v249
  v_cvt_pk_bf16_f32 v249, v250, v251
  v_cvt_pk_bf16_f32 v250, v252, v253
  v_cvt_pk_bf16_f32 v251, v254, v255
  buffer_store_dwordx4 v[248:251], v1, s[32:35], s77 offen offset:3328 sc0 sc1 nt
L_rest:
  s_cmp_ge_u32 s59, 9
  s_cbranch_scc1 L_fin
  s_call_b64 s[60:61], L_combB
L_cs27:
  s_branch L_rest
L_fin:
  s_endpgm
L_combB:
  s_cmp_lt_u32 s59, 4
  s_cbranch_scc0 L_cb_4_9
  s_cmp_lt_u32 s59, 2
  s_cbranch_scc0 L_cb_2_4
  s_cmp_lt_u32 s59, 1
  s_cbranch_scc0 L_cb_1_2
  s_mov_b32 s59, 1
  ds_read_b128 v[20:23], v2 offset:51456
  ds_read_b128 v[24:27], v2 offset:51584
  ds_read_b128 v[28:31], v2 offset:51712
  ds_read_b64 v[62:63], v7 offset:51840
  s_setpc_b64 s[60:61]
L_cb_1_2:
  s_mov_b32 s59, 2
  s_waitcnt lgkmcnt(0)
  v_and_b32 v18, v57, v62
  v_and_b32 v19, v0, v62
  s_nop 0
  s_setprio 3
  v_mfma_f32_4x4x4_16b_bf16 v[64:67], v[18:19], v[20:21], v[64:67]
  v_mfma_f32_4x4x4_16b_bf16 v[68:71], v[18:19], v[22:23], v[68:71]
  v_mfma_f32_4x4x4_16b_bf16 v[72:75], v[18:19], v[24:25], v[72:75]
  v_mfma_f32_4x4x4_16b_bf16 v[76:79], v[18:19], v[26:27], v[76:79]
  v_mfma_f32_4x4x4_16b_bf16 v[80:83], v[18:19], v[28:29], v[80:83]
  v_mfma_f32_4x4x4_16b_bf16 v[84:87], v[18:19], v[30:31], v[84:87]
  s_setprio 0
  ds_read_b128 v[20:23], v2 offset:54656
  ds_read_b128 v[24:27], v2 offset:54784
  ds_read_b128 v[28:31], v2 offset:54912
  ds_read_b64 v[62:63], v7 offset:55040
  s_setpc_b64 s[60:61]
L_cb_2_4:
  s_cmp_lt_u32 s59, 3
  s_cbranch_scc0 L_cb_3_4
  s_mov_b32 s59, 3
  v_cvt_pk_bf16_f32 v64, v64, v65
  v_cvt_pk_bf16_f32 v65, v66, v67
  v_cvt_pk_bf16_f32 v66, v68, v69
  v_cvt_pk_bf16_f32 v67, v70, v71
  buffer_store_dwordx4 v[64:67], v1, s[32:35], s68 offen offset:0 sc0 sc1 nt
  v_cvt_pk_bf16_f32 v72, v72, v73
  v_cvt_pk_bf16_f32 v73, v74, v75
  v_cvt_pk_bf16_f32 v74, v76, v77
  v_cvt_pk_bf16_f32 v75, v78, v79
  buffer_store_dwordx4 v[72:75], v1, s[32:35], s68 offen offset:128 sc0 sc1 nt
  v_cvt_pk_bf16_f32 v80, v80, v81
  v_cvt_pk_bf16_f32 v81, v82, v83
  v_cvt_pk_bf16_f32 v82, v84, v85
  v_cvt_pk_bf16_f32 v83, v86, v87
  buffer_store_dwordx4 v[80:83], v1, s[32:35], s68 offen offset:256 sc0 sc1 nt
  s_setpc_b64 s[60:61]
L_cb_3_4:
  s_mov_b32 s59, 4
  s_waitcnt lgkmcnt(0)
  v_and_b32 v18, v57, v62
  v_and_b32 v19, v0, v62
  s_nop 0
  s_setprio 3
  v_mfma_f32_4x4x4_16b_bf16 v[88:91], v[18:19], v[22:23], v[88:91]
  v_mfma_f32_4x4x4_16b_bf16 v[92:95], v[18:19], v[20:21], v[92:95]
  v_mfma_f32_4x4x4_16b_bf16 v[96:99], v[18:19], v[26:27], v[96:99]
  v_mfma_f32_4x4x4_16b_bf16 v[100:103], v[18:19], v[24:25], v[100:103]
  v_mfma_f32_4x4x4_16b_bf16 v[104:107], v[18:19], v[30:31], v[104:107]
  v_mfma_f32_4x4x4_16b_bf16 v[108:111], v[18:19], v[28:29], v[108:111]
  s_setprio 0
  ds_read_b128 v[20:23], v2 offset:57920
  ds_read_b128 v[24:27], v2 offset:58048
  ds_read_b128 v[28:31], v2 offset:58176
  ds_read_b64 v[62:63], v7 offset:58304
  s_setpc_b64 s[60:61]
L_cb_4_9:
  s_cmp_lt_u32 s59, 6
  s_cbranch_scc0 L_cb_6_9
  s_cmp_lt_u32 s59, 5
  s_cbranch_scc0 L_cb_5_6
  s_mov_b32 s59, 5
  v_cvt_pk_bf16_f32 v88, v88, v89
  v_cvt_pk_bf16_f32 v89, v90, v91
  v_cvt_pk_bf16_f32 v90, v92, v93
  v_cvt_pk_bf16_f32 v91, v94, v95
  buffer_store_dwordx4 v[88:91], v1, s[32:35], s68 offen offset:3072 sc0 sc1 nt
  v_cvt_pk_bf16_f32 v96, v96, v97
  v_cvt_pk_bf16_f32 v97, v98, v99
  v_cvt_pk_bf16_f32 v98, v100, v101
  v_cvt_pk_bf16_f32 v99, v102, v103
  buffer_store_dwordx4 v[96:99], v1, s[32:35], s68 offen offset:3200 sc0 sc1 nt
  v_cvt_pk_bf16_f32 v104, v104, v105
  v_cvt_pk_bf16_f32 v105, v106, v107
  v_cvt_pk_bf16_f32 v106, v108, v109
  v_cvt_pk_bf16_f32 v107, v110, v111
  buffer_store_dwordx4 v[104:107], v1, s[32:35], s68 offen offset:3328 sc0 sc1 nt
  s_setpc_b64 s[60:61]
L_cb_5_6:
  s_mov_b32 s59, 6
  s_waitcnt lgkmcnt(0)
  v_and_b32 v18, v57, v62
  v_and_b32 v19, v0, v62
  s_nop 0
  s_setprio 3
  v_mfma_f32_4x4x4_16b_bf16 v[112:115], v[18:19], v[20:21], v[112:115]
  v_mfma_f32_4x4x4_16b_bf16 v[116:119], v[18:19], v[22:23], v[116:119]
  v_mfma_f32_4x4x4_16b_bf16 v[120:123], v[18:19], v[24:25], v[120:123]
  v_mfma_f32_4x4x4_16b_bf16 v[124:127], v[18:19], v[26:27], v[124:127]
  v_mfma_f32_4x4x4_16b_bf16 v[128:131], v[18:19], v[28:29], v[128:131]
  v_mfma_f32_4x4x4_16b_bf16 v[132:135], v[18:19], v[30:31], v[132:135]
  s_setprio 0
  ds_read_b128 v[20:23], v2 offset:61120
  ds_read_b128 v[24:27], v2 offset:61248
  ds_read_b128 v[28:31], v2 offset:61376
  ds_read_b64 v[62:63], v7 offset:61504
  s_setpc_b64 s[60:61]
L_cb_6_9:
  s_cmp_lt_u32 s59, 7
  s_cbranch_scc0 L_cb_7_9
  s_mov_b32 s59, 7
  v_cvt_pk_bf16_f32 v112, v112, v113
  v_cvt_pk_bf16_f32 v113, v114, v115
  v_cvt_pk_bf16_f32 v114, v116, v117
  v_cvt_pk_bf16_f32 v115, v118, v119
  buffer_store_dwordx4 v[112:115], v1, s[32:35], s76 offen offset:0 sc0 sc1 nt
  v_cvt_pk_bf16_f32 v120, v120, v121
  v_cvt_pk_bf16_f32 v121, v122, v123
  v_cvt_pk_bf16_f32 v122, v124, v125
  v_cvt_pk_bf16_f32 v123, v126, v127
  buffer_store_dwordx4 v[120:123], v1, s[32:35], s76 offen offset:128 sc0 sc1 nt
  v_cvt_pk_bf16_f32 v128, v128, v129
  v_cvt_pk_bf16_f32 v129, v130, v131
  v_cvt_pk_bf16_f32 v130, v132, v133
  v_cvt_pk_bf16_f32 v131, v134, v135
  buffer_store_dwordx4 v[128:131], v1, s[32:35], s76 offen offset:256 sc0 sc1 nt
  s_setpc_b64 s[60:61]
L_cb_7_9:
  s_cmp_lt_u32 s59, 8
  s_cbranch_scc0 L_cb_8_9
  s_mov_b32 s59, 8
  s_waitcnt lgkmcnt(0)
  v_and_b32 v18, v57, v62
  v_and_b32 v19, v0, v62
  s_nop 0
  s_setprio 3
  v_mfma_f32_4x4x4_16b_bf16 v[136:139], v[18:19], v[22:23], v[136:139]
  v_mfma_f32_4x4x4_16b_bf16 v[140:143], v[18:19], v[20:21], v[140:143]
  v_mfma_f32_4x4x4_16b_bf16 v[144:147], v[18:19], v[26:27], v[144:147]
  v_mfma_f32_4x4x4_16b_bf16 v[148:151], v[18:19], v[24:25], v[148:151]
  v_mfma_f32_4x4x4_16b_bf16 v[152:155], v[18:19], v[30:31], v[152:155]
  v_mfma_f32_4x4x4_16b_bf16 v[156:159], v[18:19], v[28:29], v[156:159]
  s_setprio 0
  s_setpc_b64 s[60:61]
L_cb_8_9:
  s_mov_b32 s59, 9
  v_cvt_pk_bf16_f32 v136, v136, v137
  v_cvt_pk_bf16_f32 v137, v138, v139
  v_cvt_pk_bf16_f32 v138, v140, v141
  v_cvt_pk_bf16_f32 v139, v142, v143
  buffer_store_dwordx4 v[136:139], v1, s[32:35], s76 offen offset:3072 sc0 sc1 nt
  v_cvt_pk_bf16_f32 v144, v144, v145
  v_cvt_pk_bf16_f32 v145, v146, v147
  v_cvt_pk_bf16_f32 v146, v148, v149
  v_cvt_pk_bf16_f32 v147, v150, v151
  buffer_store_dwordx4 v[144:147], v1, s[32:35], s76 offen offset:3200 sc0 sc1 nt
  v_cvt_pk_bf16_f32 v152, v152, v153
  v_cvt_pk_bf16_f32 v153, v154, v155
  v_cvt_pk_bf16_f32 v154, v156, v157
  v_cvt_pk_bf16_f32 v155, v158, v159
  buffer_store_dwordx4 v[152:155], v1, s[32:35], s76 offen offset:3328 sc0 sc1 nt
  s_mov_b32 s58, 1000
  s_setpc_b64 s[60:61]
L_exit:
  s_endpgm
L_code_end:
.section .rodata,"a"
.p2align 6
.amdhsa_kernel standalone__memory_aug_memorizing_tr__prompt_kernel
  .amdhsa_next_free_vgpr 256
  .amdhsa_next_free_sgpr 102
  .amdhsa_accum_offset 256
  .amdhsa_group_segment_fixed_size 0
  .amdhsa_kernarg_size 80
  .amdhsa_user_sgpr_count 2
  .amdhsa_user_sgpr_kernarg_segment_ptr 1
  .amdhsa_system_sgpr_workgroup_id_x 1
.end_amdhsa_kernel
```
